```python
import torch

def _softmax(x, axis=-1):
    return torch.softmax(x, dim=axis)
def _gelu(x):
    return torch.nn.functional.gelu(x, approximate="tanh")
def _silu(x):
    return torch.nn.functional.silu(x)
def _sigmoid(x):
    return torch.sigmoid(x)
def _layernorm(x, axis=-1, eps=1e-5):
    m = x.mean(dim=axis, keepdim=True)
    v = x.var(dim=axis, keepdim=True, unbiased=False)
    return (x - m) / torch.sqrt(v + eps)
def _scatter_add(tgt, idx, src, axis=0):
    return tgt.clone().index_add_(axis, idx, src)
def _segment_sum(src, seg, n):
    out = torch.zeros((n,) + src.shape[1:], dtype=src.dtype)
    return out.index_add_(0, seg, src)
def _pad(x, pw):
    flat = tuple(v for pair in reversed(pw) for v in pair)
    return torch.nn.functional.pad(x, flat)

kernel_name = 'concat_heads__spectral_fnet__sliding_block__prompt'

def setup_inputs():

    _w = (lambda a: (lambda t: t.to(torch.bfloat16) if t.is_floating_point() else t)(torch.as_tensor(a)))
    def _A_setup():
        B, S, D = 1, 2048, 512
        ns = torch.arange(S)[:, None] * torch.arange(S)[None, :]
        nd = torch.arange(D)[:, None] * torch.arange(D)[None, :]
        Ws_re = torch.cos(-2.0 * torch.pi * ns / S).to(float)
        Ws_im = torch.sin(-2.0 * torch.pi * ns / S).to(float)
        Wd_re = torch.cos(-2.0 * torch.pi * nd / D).to(float)
        Wd_im = torch.sin(-2.0 * torch.pi * nd / D).to(float)
        return {
            "x": _w((lambda *s: torch.randn(*s, dtype=torch.bfloat16) * 0.05)(B, S, D)),
            "dft_seq_re": _w(Ws_re),
            "dft_seq_im": _w(Ws_im),
            "dft_hid_re": _w(Wd_re),
            "dft_hid_im": _w(Wd_im),
        }
    _A_in = _A_setup()

    def _B_setup():
        B, S, D = 1, 2048, 512
        return {
            "x": _w((lambda *s: torch.randn(*s, dtype=torch.bfloat16) * 0.2)(B, S, D)),
            "wqkv": _w((lambda *s: torch.randn(*s, dtype=torch.bfloat16) * 0.8)(D, 3 * D)),
            "wo": _w((lambda *s: torch.randn(*s, dtype=torch.bfloat16) * 0.2)(D, D)),
        }
    _B_in = _B_setup()

    return {
        "A_x": _A_in["x"],
        "A_dft_seq_re": _A_in["dft_seq_re"],
        "A_dft_seq_im": _A_in["dft_seq_im"],
        "A_dft_hid_re": _A_in["dft_hid_re"],
        "A_dft_hid_im": _A_in["dft_hid_im"],
        "B_x": _B_in["x"],
        "B_wqkv": _B_in["wqkv"],
        "B_wo": _B_in["wo"],
    }

def reference(A_x, A_dft_seq_re, A_dft_seq_im, A_dft_hid_re, A_dft_hid_im, B_x, B_wqkv, B_wo):
    def _A_ref(x, dft_seq_re, dft_seq_im, dft_hid_re, dft_hid_im):
        a = torch.einsum("bsd,ed->bse", x, dft_hid_re)
        b = torch.einsum("bsd,ed->bse", x, dft_hid_im)
        y = torch.einsum("ts,bse->bte", dft_seq_re, a) - torch.einsum("ts,bse->bte", dft_seq_im, b)
        return y

    def _B_ref(x, wqkv, wo):
        B, S, D = x.shape
        H = 32; Dh = D // H; W = 256
        qkv = (lambda x, *d: x.permute(*d))((x @ wqkv).reshape(B, S, 3, H, Dh), 2, 0, 3, 1, 4)
        q, k, v = qkv[0], qkv[1], qkv[2]
        scores = torch.einsum("bhqd,bhkd->bhqk", q, k) * (Dh ** -0.5)
        idx = torch.arange(S)
        mask = (idx[:, None] - idx[None, :] >= 0) & (idx[:, None] - idx[None, :] < W)
        scores = torch.where(mask[None, None], scores, -1e9)
        p = _softmax(scores, axis=-1)
        o = torch.einsum("bhqk,bhkd->bhqd", p, v)
        return (lambda x, *d: x.permute(*d))(o, 0, 2, 1, 3).reshape(B, S, D) @ wo

    a = _A_ref(A_x, A_dft_seq_re, A_dft_seq_im, A_dft_hid_re, A_dft_hid_im)
    b = _B_ref(B_x, B_wqkv, B_wo)
    return torch.concatenate([a, b], axis=-1)
```

```asm
; @launch grid=(256,1,1) block=(768,1,1) lds=163840
.amdgcn_target "amdgcn-amd-amdhsa--gfx950"
.text
.globl concat_heads__spectral_fnet__sliding_block__prompt_kernel
.p2align 8
.type concat_heads__spectral_fnet__sliding_block__prompt_kernel,@function
concat_heads__spectral_fnet__sliding_block__prompt_kernel:
  s_cmp_ge_u32 s2, 256
  s_cbranch_scc1 L_end
  s_load_dwordx16 s[64:79], s[0:1], 0
  s_load_dwordx4 s[80:83], s[0:1], 64
  s_load_dwordx2 s[84:85], s[0:1], 80
  v_lshrrev_b32 v1, 6, v0
  v_and_b32 v0, 63, v0
  s_and_b32 s22, s2, 7
  v_readfirstlane_b32 s19, v1
  s_lshr_b32 s18, s2, 3
  s_lshl_b32 s3, s22, 2
  s_and_b32 s4, s18, 3
  s_add_u32 s16, s3, s4
  s_lshr_b32 s17, s2, 5
  s_xor_b32 s17, s17, 0
  s_cmp_lt_u32 s19, 8
  s_cbranch_scc1 L_consumer
  s_sub_u32 s23, s19, 8
  s_lshl_b32 s3, s16, 2
  s_add_u32 s3, s3, s23
  s_lshl_b32 s3, s3, 14
  v_lshrrev_b32 v1, 3, v0
  v_and_b32 v2, 7, v0
  v_lshrrev_b32 v3, 4, v0
  v_xor_b32 v4, v3, v2
  v_xor_b32 v5, 4, v4
  v_lshlrev_b32 v4, 4, v4
  v_lshlrev_b32 v5, 4, v5
  v_lshl_add_u32 v6, v1, 10, s3
  v_add_u32 v8, v6, v4
  v_add_u32 v9, v6, v5
  v_add_u32 v9, 8192, v9
  v_and_b32 v6, 1, v3
  v_lshlrev_b32 v6, 2, v6
  v_xor_b32 v6, v6, v2
  s_lshl_b32 s3, s17, 7
  v_lshl_add_u32 v6, v6, 4, s3
  s_and_b32 s3, s23, 1
  s_lshl_b32 s3, s3, 5
  v_add_u32 v7, s3, v1
  s_movk_i32 s3, 3072
  v_mad_u32_u24 v10, v7, s3, v6
  v_add_u32 v11, 24576, v10
  v_add_u32 v12, 49152, v10
  v_add_u32 v13, 73728, v10
  s_and_b32 s3, s18, 3
  s_lshl_b32 s3, s3, 1
  s_add_u32 s3, s3, s17
  s_and_b32 s3, s3, 4
  s_add_u32 s3, s3, s22
  s_and_b32 s15, s3, 7
  s_nop 0
  s_lshr_b32 s27, s23, 1
  s_lshl_b32 s27, s27, 10
  s_add_u32 s27, s27, 1024
  s_lshl_b32 s28, s15, 7
  s_mul_i32 s29, s15, 196608
  s_add_u32 s29, s29, s27
  s_lshl_b32 s30, s23, 11
  s_lshl_b32 s31, s23, 12
  s_waitcnt lgkmcnt(0)
  s_mov_b32 s36, s74
  s_mov_b32 s37, s75
  s_mov_b32 s38, 2097152
  s_mov_b32 s39, 0x20000
  s_mov_b32 s40, s76
  s_mov_b32 s41, s77
  s_mov_b32 s42, 1572864
  s_mov_b32 s43, 0x20000
  s_add_u32 m0, s30, 0
  s_nop 0
  buffer_load_dwordx4 v8, s[36:39], s28 offen lds
  s_add_u32 m0, s30, 1024
  s_nop 0
  buffer_load_dwordx4 v9, s[36:39], s28 offen lds
  s_add_u32 m0, s31, 65536
  s_nop 0
  buffer_load_dwordx4 v10, s[40:43], s29 offen lds
  s_add_u32 m0, s31, 66560
  s_nop 0
  buffer_load_dwordx4 v11, s[40:43], s29 offen lds
  s_add_u32 m0, s31, 67584
  s_nop 0
  buffer_load_dwordx4 v12, s[40:43], s29 offen lds
  s_add_u32 m0, s31, 68608
  s_nop 0
  buffer_load_dwordx4 v13, s[40:43], s29 offen lds
  s_lshl_b32 s3, s16, 1
  s_lshr_b32 s4, s23, 1
  s_add_u32 s3, s3, s4
  s_lshl_b32 s3, s3, 10
  s_and_b32 s4, s23, 1
  s_lshl_b32 s4, s4, 20
  s_add_u32 s3, s3, s4
  v_lshl_add_u32 v6, v1, 16, s3
  v_add_u32 v14, v6, v4
  v_add_u32 v15, v6, v5
  v_add_u32 v15, 524288, v15
  s_lshr_b32 s3, s18, 2
  s_and_b32 s21, s3, 6
  s_lshl_b32 s25, s21, 7
  s_mov_b32 s48, s64
  s_mov_b32 s49, s65
  s_mov_b32 s50, 2097152
  s_mov_b32 s51, 0x20000
  s_add_u32 m0, s30, 81920
  s_nop 0
  buffer_load_dwordx4 v14, s[48:51], s25 offen lds
  s_add_u32 m0, s30, 82944
  s_nop 0
  buffer_load_dwordx4 v15, s[48:51], s25 offen lds
  s_add_u32 s15, s15, 1
  s_and_b32 s15, s15, 7
  s_lshl_b32 s28, s15, 7
  s_mul_i32 s29, s15, 196608
  s_add_u32 s29, s29, s27
  s_add_u32 s25, s25, 128
  s_and_b32 s25, s25, 1023
  s_mov_b32 s32, s84
  s_mov_b32 s33, s85
  s_mov_b32 s34, 16777216
  s_mov_b32 s35, 0x20000
  s_mov_b32 s56, s82
  s_mov_b32 s57, s83
  s_mov_b32 s58, 256
  s_mov_b32 s59, 0x20000
  v_and_b32 v6, 1, v3
  v_lshlrev_b32 v6, 2, v6
  v_xor_b32 v6, v6, v2
  s_lshl_b32 s3, s23, 17
  s_lshl_b32 s4, s17, 7
  s_add_u32 s3, s3, s4
  v_lshl_add_u32 v6, v6, 4, s3
  v_lshl_add_u32 v19, v1, 10, v6
  v_lshrrev_b32 v4, 1, v0
  v_add_u32 v4, s16, v4
  v_subrev_u32 v4, 4, v4
  v_and_b32 v5, 3, v4
  v_bfe_u32 v4, v4, 2, 3
  v_lshl_add_u32 v4, v5, 3, v4
  s_lshr_b32 s4, s2, 5
  s_lshl_b32 s4, s4, 12
  s_and_b32 s5, s23, 2
  s_lshl_b32 s5, s5, 2
  s_add_u32 s4, s4, s5
  v_lshl_add_u32 v4, v4, 7, s4
  v_and_b32 v5, 1, v0
  v_lshl_add_u32 v4, v5, 2, v4
  v_add_u32 v16, 11534336, v4
  v_lshlrev_b32 v1, 4, v0
  s_lshl_b32 s9, s17, 2
  s_add_u32 s9, s9, s23
  s_lshl_b32 s5, s16, 11
  s_lshl_b32 s6, s9, 16
  s_add_u32 s10, s5, s6
  s_add_u32 s5, s10, 6291456
  v_lshl_add_u32 v24, v0, 7, s5
  s_lshl_b32 s4, s16, 6
  s_lshl_b32 s5, s23, 3
  s_add_u32 s4, s4, s5
  v_bfe_u32 v4, v0, 1, 3
  v_and_b32 v5, 1, v0
  v_lshl_add_u32 v4, v5, 5, v4
  v_add_u32 v4, s4, v4
  v_lshlrev_b32 v4, 2, v4
  v_add_u32 v25, 11665408, v4
  s_lshl_b32 s5, s23, 19
  s_lshl_b32 s6, s16, 11
  s_add_u32 s5, s5, s6
  s_add_u32 s13, s5, 6291456
  s_lshl_b32 s4, s2, 1
  s_lshr_b32 s5, s23, 1
  s_add_u32 s4, s4, s5
  s_mul_i32 s4, s4, 3072
  s_and_b32 s5, s23, 1
  s_lshl_b32 s5, s5, 9
  s_add_u32 s5, s5, s4
  s_add_u32 s52, s76, s5
  s_addc_u32 s53, s77, 0
  s_mov_b32 s55, 0
  s_mov_b32 s54, 114688
  s_add_u32 s11, s30, 16384
  s_getreg_b32 s14, hwreg(HW_REG_XCC_ID, 0, 16)
  s_lshl_b32 s14, s14, 8
  s_lshl_b32 s3, s2, 7
  s_add_u32 s3, s3, 11534336
  s_lshr_b32 s4, s18, 2
  s_lshl_b32 s4, s4, 8
  s_lshr_b32 s5, s16, 4
  s_lshl_b32 s5, s5, 7
  s_add_u32 s4, s4, s5
  s_add_u32 s4, s4, 11993088
  s_bitcmp1_b32 s23, 0
  s_cselect_b32 s3, s4, s3
  s_add_u32 s4, s32, s3
  s_addc_u32 s5, s33, 0
  s_load_dword s61, s[4:5], 0
  s_load_dword s61, s[4:5], 64
  s_add_u32 m0, s30, 8192
  s_nop 0
  buffer_load_dwordx4 v8, s[36:39], s28 offen lds
  s_add_u32 m0, s30, 9216
  s_nop 0
  buffer_load_dwordx4 v9, s[36:39], s28 offen lds
  s_add_u32 m0, s31, 90112
  s_nop 0
  buffer_load_dwordx4 v10, s[40:43], s29 offen lds
  s_add_u32 m0, s31, 91136
  s_nop 0
  buffer_load_dwordx4 v11, s[40:43], s29 offen lds
  s_add_u32 m0, s31, 92160
  s_nop 0
  buffer_load_dwordx4 v12, s[40:43], s29 offen lds
  s_add_u32 m0, s31, 93184
  s_nop 0
  buffer_load_dwordx4 v13, s[40:43], s29 offen lds
  s_add_u32 m0, s30, 106496
  s_nop 0
  buffer_load_dwordx4 v14, s[48:51], s25 offen lds
  s_add_u32 m0, s30, 107520
  s_nop 0
  buffer_load_dwordx4 v15, s[48:51], s25 offen lds
  s_add_u32 s15, s15, 1
  s_and_b32 s15, s15, 7
  s_lshl_b32 s28, s15, 7
  s_mul_i32 s29, s15, 196608
  s_add_u32 s29, s29, s27
  s_add_u32 s25, s25, 128
  s_and_b32 s25, s25, 1023
.p2align 6
L_hl:
  s_waitcnt vmcnt(8)
  s_barrier
  s_add_u32 s4, s31, s54
  s_add_u32 s5, s30, s54
  s_add_u32 m0, s11, 0
  s_nop 0
  buffer_load_dwordx4 v8, s[36:39], s28 offen lds
  s_add_u32 m0, s11, 1024
  s_nop 0
  buffer_load_dwordx4 v9, s[36:39], s28 offen lds
  s_add_u32 m0, s4, 0
  s_nop 0
  buffer_load_dwordx4 v10, s[40:43], s29 offen lds
  s_add_u32 m0, s4, 1024
  s_nop 0
  buffer_load_dwordx4 v11, s[40:43], s29 offen lds
  s_add_u32 m0, s4, 2048
  s_nop 0
  buffer_load_dwordx4 v12, s[40:43], s29 offen lds
  s_add_u32 m0, s4, 3072
  s_nop 0
  buffer_load_dwordx4 v13, s[40:43], s29 offen lds
  s_add_u32 m0, s5, 16384
  s_nop 0
  buffer_load_dwordx4 v14, s[48:51], s25 offen lds
  s_add_u32 m0, s5, 17408
  s_nop 0
  buffer_load_dwordx4 v15, s[48:51], s25 offen lds
  s_sub_u32 s3, s55, 2
  s_cmp_ge_u32 s3, 4
  s_cbranch_scc1 L_hpf
  s_load_dword s61, s[52:53], 0
  s_load_dword s61, s[52:53], 64
  s_load_dword s61, s[52:53], 128
  s_load_dword s61, s[52:53], 192
  s_add_u32 s52, s52, 256
  s_addc_u32 s53, s53, 0
  s_cmp_lg_u32 s3, 1
  s_cbranch_scc1 L_hpf
  s_lshl_b32 s4, s2, 2
  s_add_u32 s4, s4, s23
  s_lshl_b32 s5, s4, 9
  s_add_u32 s52, s78, s5
  s_addc_u32 s53, s79, 0
L_hpf:
  s_add_u32 s11, s11, 8192
  s_add_u32 s54, s54, 24576
  s_cmp_eq_u32 s54, 139264
  s_cselect_b32 s54, 65536, s54
  s_add_u32 s15, s15, 1
  s_and_b32 s15, s15, 7
  s_lshl_b32 s28, s15, 7
  s_mul_i32 s29, s15, 196608
  s_add_u32 s29, s29, s27
  s_add_u32 s25, s25, 128
  s_and_b32 s25, s25, 1023
  s_add_u32 s55, s55, 1
  s_cmp_lt_u32 s55, 6
  s_cbranch_scc1 L_hl
  s_lshr_b32 s3, s23, 1
  s_add_u32 s15, s15, s3
  s_and_b32 s15, s15, 7
  s_mul_i32 s29, s15, 196608
  s_cmp_lg_u32 s23, 0
  s_cbranch_scc1 L_hn0
  buffer_load_dword v18, off, s[56:59], 0 sc1
  s_waitcnt vmcnt(9)
  s_branch L_hn1
L_hn0:
  s_waitcnt vmcnt(8)
L_hn1:
  s_barrier
  s_add_u32 m0, s31, 114688
  s_nop 0
  buffer_load_dwordx4 v10, s[40:43], s29 offen lds
  s_add_u32 m0, s31, 115712
  s_nop 0
  buffer_load_dwordx4 v11, s[40:43], s29 offen lds
  s_add_u32 m0, s31, 116736
  s_nop 0
  buffer_load_dwordx4 v12, s[40:43], s29 offen lds
  s_add_u32 m0, s31, 117760
  s_nop 0
  buffer_load_dwordx4 v13, s[40:43], s29 offen lds
  s_add_u32 s15, s15, 2
  s_and_b32 s15, s15, 7
  s_mul_i32 s29, s15, 196608
  s_cmp_lg_u32 s23, 0
  s_cbranch_scc1 L_hn2
  s_waitcnt vmcnt(5)
  s_branch L_hn3
L_hn2:
  s_waitcnt vmcnt(4)
L_hn3:
  s_barrier
  s_add_u32 m0, s31, 65536
  s_nop 0
  buffer_load_dwordx4 v10, s[40:43], s29 offen lds
  s_add_u32 m0, s31, 66560
  s_nop 0
  buffer_load_dwordx4 v11, s[40:43], s29 offen lds
  s_add_u32 m0, s31, 67584
  s_nop 0
  buffer_load_dwordx4 v12, s[40:43], s29 offen lds
  s_add_u32 m0, s31, 68608
  s_nop 0
  buffer_load_dwordx4 v13, s[40:43], s29 offen lds
  s_add_u32 s15, s15, 2
  s_and_b32 s15, s15, 7
  s_mul_i32 s29, s15, 196608
  s_add_u32 m0, s31, 139264
  s_nop 0
  buffer_load_dwordx4 v10, s[40:43], s29 offen lds
  s_add_u32 m0, s31, 140288
  s_nop 0
  buffer_load_dwordx4 v11, s[40:43], s29 offen lds
  s_add_u32 m0, s31, 141312
  s_nop 0
  buffer_load_dwordx4 v12, s[40:43], s29 offen lds
  s_add_u32 m0, s31, 142336
  s_nop 0
  buffer_load_dwordx4 v13, s[40:43], s29 offen lds
  s_add_u32 s15, s15, 2
  s_and_b32 s15, s15, 7
  s_mul_i32 s29, s15, 196608
  s_waitcnt vmcnt(8)
  s_cmp_lg_u32 s23, 0
  s_cbranch_scc1 L_hp2
  s_mov_b32 s60, 0
  s_branch non1c
non1:
  buffer_load_dword v18, off, s[56:59], 0 sc1
  s_waitcnt vmcnt(0)
non1c:
  v_readfirstlane_b32 s20, v18
  s_add_u32 s60, s60, 1
  s_cmp_gt_u32 s60, 200000
  s_cbranch_scc1 non1x
  s_cmp_eq_u32 s20, 0
  s_cbranch_scc1 non1
non1x:
  v_mov_b32 v6, 162816
  v_mov_b32 v7, s20
  ds_write_b32 v6, v7
  v_mov_b32 v44, 0
  v_mov_b32 v45, 0
  ds_write_b64 v6, v[44:45] offset:16
  s_xor_b32 s3, s14, s20
  v_mov_b32 v18, s3
  s_lshl_b32 s3, s22, 5
  s_add_u32 s3, s3, s18
  s_lshl_b32 s3, s3, 2
  s_add_u32 s3, s3, 11927552
  s_mov_b64 exec, 1
  buffer_store_dword v18, off, s[32:35], s3
  s_mov_b64 exec, -1
  s_waitcnt lgkmcnt(0)
L_hp2:
  s_barrier
  s_add_u32 m0, s31, 90112
  s_nop 0
  buffer_load_dwordx4 v10, s[40:43], s29 offen lds
  s_add_u32 m0, s31, 91136
  s_nop 0
  buffer_load_dwordx4 v11, s[40:43], s29 offen lds
  s_add_u32 m0, s31, 92160
  s_nop 0
  buffer_load_dwordx4 v12, s[40:43], s29 offen lds
  s_add_u32 m0, s31, 93184
  s_nop 0
  buffer_load_dwordx4 v13, s[40:43], s29 offen lds
  s_mov_b64 exec, 0xffff
  buffer_load_dword v27, v24, s[32:35], 0 offen
  buffer_load_dword v26, v25, s[32:35], 0 offen sc1
  s_mov_b64 exec, -1
  v_mov_b32 v6, 162816
  ds_read_b32 v6, v6
  s_waitcnt lgkmcnt(0)
  v_readfirstlane_b32 s20, v6
  s_nop 1
  s_mov_b32 s44, s78
  s_mov_b32 s45, s79
  s_mov_b32 s46, 524288
  s_mov_b32 s47, 0x20000
  s_mov_b32 s40, s80
  s_mov_b32 s41, s81
  s_mov_b32 s42, 4194304
  s_mov_b32 s43, 0x20000
  s_lshl_b32 s6, s22, 1
  s_and_b32 s4, s18, 1
  s_add_u32 s6, s6, s4
  s_lshr_b32 s7, s18, 1
  s_lshl_b32 s24, s7, 5
  s_lshr_b32 s4, s6, 2
  s_lshl_b32 s4, s4, 3
  s_and_b32 s5, s6, 3
  s_add_u32 s4, s4, s5
  s_and_b32 s5, s19, 1
  s_lshl_b32 s5, s5, 2
  s_add_u32 s5, s4, s5
  s_sub_u32 s4, 32, s5
  s_and_b32 s4, s4, 31
  s_cmp_lt_u32 s2, 128
  s_cselect_b32 s11, s5, s4
  s_cselect_b64 vcc, -1, 0
  v_and_b32 v45, 31, v0
  v_lshl_add_u32 v20, v45, 5, s11
  v_lshrrev_b32 v47, 5, v0
  v_and_b32 v45, 0x13, v0
  v_bfe_u32 v46, v0, 2, 1
  v_lshl_or_b32 v45, v46, 3, v45
  v_bfe_u32 v46, v0, 3, 1
  v_lshl_or_b32 v45, v46, 2, v45
  v_add_u32 v45, s24, v45
  v_sub_u32 v46, 512, v45
  v_cndmask_b32 v45, v46, v45, vcc
  s_mul_i32 s4, s6, 4224
  s_and_b32 s5, s19, 1
  s_lshl_b32 s5, s5, 3
  s_add_u32 s4, s4, s5
  s_add_u32 s4, s4, 8388608
  v_lshl_add_u32 v45, v45, 4, s4
  s_mov_b32 s5, 1081344
  v_mad_u32_u24 v22, v47, s5, v45
  s_sub_u32 s5, 15, s7
  s_cmp_lt_u32 s2, 128
  s_cselect_b32 s4, s7, s5
  s_cselect_b32 s5, 0, 1
  v_mul_u32_u24 v45, s5, v47
  v_add_u32 v45, s4, v45
  v_and_b32 v45, 7, v45
  v_and_b32 v46, 31, v0
  v_lshlrev_b32 v46, 3, v46
  v_lshl_add_u32 v45, v45, 8, v46
  v_add_u32 v21, 11993088, v45
  s_sub_u32 s3, 4, s16
  s_max_i32 s3, s3, 0
  s_lshl_b32 s4, s3, 1
  s_lshl_b32 s6, 0xff, s4
  s_and_b32 s6, s6, 0xff
  s_mov_b32 s7, 0
  s_mul_i32 s8, s23, 20480
  s_add_u32 s8, s8, 6144
  s_add_u32 s10, s10, 2095104
  s_lshl_b32 s30, s23, 14
  v_mov_b32 v2, 0x7ffffff0
  s_waitcnt vmcnt(10) lgkmcnt(0)
  s_barrier
  s_waitcnt vmcnt(6)
  s_barrier
  s_waitcnt vmcnt(2)
  s_barrier
  s_mov_b64 exec, s[6:7]
  s_cbranch_execz L_kv0
  buffer_load_dword v5, v16, s[32:35], 0 offen sc1
  s_mov_b64 exec, -1
  s_barrier
  s_mov_b64 exec, s[6:7]
  s_waitcnt vmcnt(0)
  v_cmp_ne_u32 vcc, s20, v5
  s_mov_b64 exec, -1
  s_cbranch_vccz L_kv1
  s_mov_b32 s60, 0
  s_mov_b64 exec, s[6:7]
poll2:
  buffer_load_dword v5, v16, s[32:35], 0 offen sc1
  s_add_u32 s60, s60, 1
  s_cmp_gt_u32 s60, 200000
  s_cbranch_scc1 poll2x
  s_waitcnt vmcnt(0)
  v_cmp_ne_u32 vcc, s20, v5
  s_cbranch_vccnz poll2
poll2x:
  s_mov_b64 exec, -1
  s_branch L_kv1
L_kv0:
  s_mov_b64 exec, -1
  s_barrier
L_kv1:
  v_mov_b32 v3, v1
  s_cmp_gt_u32 s16, 0
  s_cbranch_scc1 L_kvr0
  v_mov_b32 v3, v2
  s_mov_b32 s10, 0
L_kvr0:
  s_sub_u32 m0, s8, 0
  s_sub_u32 s4, s10, 0
  buffer_load_dwordx4 v3, s[32:35], s4 offen sc1 lds
  buffer_load_dwordx4 v3, s[32:35], s4 offen offset:1024 sc1 lds
  s_add_u32 m0, m0, 10240
  s_add_u32 s4, s4, 2097152
  buffer_load_dwordx4 v3, s[32:35], s4 offen sc1 lds
  buffer_load_dwordx4 v3, s[32:35], s4 offen offset:1024 sc1 lds
  s_cmp_gt_u32 s16, 1
  s_cbranch_scc1 L_kvr1
  v_mov_b32 v3, v2
  s_mov_b32 s10, 2048
L_kvr1:
  s_sub_u32 m0, s8, 2048
  s_sub_u32 s4, s10, 2048
  buffer_load_dwordx4 v3, s[32:35], s4 offen sc1 lds
  buffer_load_dwordx4 v3, s[32:35], s4 offen offset:1024 sc1 lds
  s_add_u32 m0, m0, 10240
  s_add_u32 s4, s4, 2097152
  buffer_load_dwordx4 v3, s[32:35], s4 offen sc1 lds
  buffer_load_dwordx4 v3, s[32:35], s4 offen offset:1024 sc1 lds
  s_lshl_b32 s3, s23, 2
  s_add_u32 s3, s3, 90112
  v_mov_b32 v6, s3
  v_mov_b32 v7, 0
  ds_write_b32 v6, v7
  s_and_b32 s3, s23, 1
  s_lshl_b32 s3, s3, 13
  s_add_u32 s3, s3, 114688
  v_add_u32 v44, s3, v1
  ds_read_b128 v[96:99], v44 offset:0
  ds_read_b128 v[100:103], v44 offset:1024
  ds_read_b128 v[104:107], v44 offset:2048
  ds_read_b128 v[108:111], v44 offset:3072
  ds_read_b128 v[112:115], v44 offset:4096
  ds_read_b128 v[116:119], v44 offset:5120
  ds_read_b128 v[120:123], v44 offset:6144
  ds_read_b128 v[124:127], v44 offset:7168
  v_mov_b32 v7, 1
  s_waitcnt lgkmcnt(0)
  s_waitcnt vmcnt(4)
  s_barrier
  s_cmp_gt_u32 s16, 2
  s_cbranch_scc1 L_kvr2
  v_mov_b32 v3, v2
  s_mov_b32 s10, 4096
L_kvr2:
  s_sub_u32 m0, s8, 4096
  s_sub_u32 s4, s10, 4096
  buffer_load_dwordx4 v3, s[32:35], s4 offen sc1 lds
  buffer_load_dwordx4 v3, s[32:35], s4 offen offset:1024 sc1 lds
  s_add_u32 m0, m0, 10240
  s_add_u32 s4, s4, 2097152
  buffer_load_dwordx4 v3, s[32:35], s4 offen sc1 lds
  buffer_load_dwordx4 v3, s[32:35], s4 offen offset:1024 sc1 lds
  s_cmp_gt_u32 s16, 3
  s_cbranch_scc1 L_kvr3
  v_mov_b32 v3, v2
  s_mov_b32 s10, 6144
L_kvr3:
  s_sub_u32 m0, s8, 6144
  s_sub_u32 s4, s10, 6144
  buffer_load_dwordx4 v3, s[32:35], s4 offen sc1 lds
  buffer_load_dwordx4 v3, s[32:35], s4 offen offset:1024 sc1 lds
  s_add_u32 m0, m0, 10240
  s_add_u32 s4, s4, 2097152
  buffer_load_dwordx4 v3, s[32:35], s4 offen sc1 lds
  buffer_load_dwordx4 v3, s[32:35], s4 offen offset:1024 sc1 lds
  s_waitcnt vmcnt(8)
  s_barrier
  buffer_load_dwordx2 v[4:5], v21, s[32:35], 0 offen sc1
  s_waitcnt vmcnt(5)
  ds_write_b32 v6, v7
  v_mov_b32 v7, 2
  s_add_u32 s3, s18, 0
  s_and_b32 s3, s3, 3
  s_lshl_b32 s4, s3, 12
  s_add_u32 s4, s4, s30
  s_add_u32 s4, s4, 98304
  s_lshl_b32 s5, s3, 15
  s_add_u32 m0, s4, 0
  s_add_u32 s6, s5, 0
  buffer_load_dwordx4 v19, s[44:47], s6 offen lds
  s_add_u32 m0, s4, 1024
  s_add_u32 s6, s5, 8192
  buffer_load_dwordx4 v19, s[44:47], s6 offen lds
  s_add_u32 m0, s4, 2048
  s_add_u32 s6, s5, 16384
  buffer_load_dwordx4 v19, s[44:47], s6 offen lds
  s_add_u32 m0, s4, 3072
  s_add_u32 s6, s5, 24576
  buffer_load_dwordx4 v19, s[44:47], s6 offen lds
  s_waitcnt vmcnt(5)
  ds_write_b32 v6, v7
  s_add_u32 s3, s18, 1
  s_and_b32 s3, s3, 3
  s_lshl_b32 s4, s3, 12
  s_add_u32 s4, s4, s30
  s_add_u32 s4, s4, 98304
  s_lshl_b32 s5, s3, 15
  s_add_u32 m0, s4, 0
  s_add_u32 s6, s5, 0
  buffer_load_dwordx4 v19, s[44:47], s6 offen lds
  s_add_u32 m0, s4, 1024
  s_add_u32 s6, s5, 8192
  buffer_load_dwordx4 v19, s[44:47], s6 offen lds
  s_add_u32 m0, s4, 2048
  s_add_u32 s6, s5, 16384
  buffer_load_dwordx4 v19, s[44:47], s6 offen lds
  s_add_u32 m0, s4, 3072
  s_add_u32 s6, s5, 24576
  buffer_load_dwordx4 v19, s[44:47], s6 offen lds
  s_add_u32 s3, s18, 2
  s_and_b32 s3, s3, 3
  s_lshl_b32 s4, s3, 12
  s_add_u32 s4, s4, s30
  s_add_u32 s4, s4, 98304
  s_lshl_b32 s5, s3, 15
  s_add_u32 m0, s4, 0
  s_add_u32 s6, s5, 0
  buffer_load_dwordx4 v19, s[44:47], s6 offen lds
  s_add_u32 m0, s4, 1024
  s_add_u32 s6, s5, 8192
  buffer_load_dwordx4 v19, s[44:47], s6 offen lds
  s_add_u32 m0, s4, 2048
  s_add_u32 s6, s5, 16384
  buffer_load_dwordx4 v19, s[44:47], s6 offen lds
  s_add_u32 m0, s4, 3072
  s_add_u32 s6, s5, 24576
  buffer_load_dwordx4 v19, s[44:47], s6 offen lds
  s_add_u32 s3, s18, 3
  s_and_b32 s3, s3, 3
  s_lshl_b32 s4, s3, 12
  s_add_u32 s4, s4, s30
  s_add_u32 s4, s4, 98304
  s_lshl_b32 s5, s3, 15
  s_add_u32 m0, s4, 0
  s_add_u32 s6, s5, 0
  buffer_load_dwordx4 v19, s[44:47], s6 offen lds
  s_add_u32 m0, s4, 1024
  s_add_u32 s6, s5, 8192
  buffer_load_dwordx4 v19, s[44:47], s6 offen lds
  s_add_u32 m0, s4, 2048
  s_add_u32 s6, s5, 16384
  buffer_load_dwordx4 v19, s[44:47], s6 offen lds
  s_add_u32 m0, s4, 3072
  s_add_u32 s6, s5, 24576
  buffer_load_dwordx4 v19, s[44:47], s6 offen lds
  s_cmp_ge_u32 s23, 2
  s_cbranch_scc1 L_nou
  s_waitcnt vmcnt(16)
  v_cmp_ne_u32 vcc, s20, v4
  v_cmp_ne_u32 s[10:11], s20, v5
  s_or_b64 vcc, vcc, s[10:11]
  s_cbranch_vccz L_uok
  s_mov_b32 s60, 0
pq3:
  buffer_load_dwordx2 v[4:5], v21, s[32:35], 0 offen sc1
  s_add_u32 s60, s60, 1
  s_cmp_gt_u32 s60, 200000
  s_cbranch_scc1 pq3x
  s_waitcnt vmcnt(0)
  v_cmp_ne_u32 vcc, s20, v4
  v_cmp_ne_u32 s[10:11], s20, v5
  s_or_b64 vcc, vcc, s[10:11]
  s_cbranch_vccnz pq3
pq3x:
L_uok:
  s_mov_b32 s4, 0
  buffer_load_dwordx2 v[64:65], v22, s[32:35], s4 offen sc1
  s_mov_b32 s4, 67584
  buffer_load_dwordx2 v[66:67], v22, s[32:35], s4 offen sc1
  s_mov_b32 s4, 135168
  buffer_load_dwordx2 v[68:69], v22, s[32:35], s4 offen sc1
  s_mov_b32 s4, 202752
  buffer_load_dwordx2 v[70:71], v22, s[32:35], s4 offen sc1
  s_mov_b32 s4, 270336
  buffer_load_dwordx2 v[72:73], v22, s[32:35], s4 offen sc1
  s_mov_b32 s4, 337920
  buffer_load_dwordx2 v[74:75], v22, s[32:35], s4 offen sc1
  s_mov_b32 s4, 405504
  buffer_load_dwordx2 v[76:77], v22, s[32:35], s4 offen sc1
  s_mov_b32 s4, 473088
  buffer_load_dwordx2 v[78:79], v22, s[32:35], s4 offen sc1
  s_mov_b32 s4, 540672
  buffer_load_dwordx2 v[80:81], v22, s[32:35], s4 offen sc1
  s_mov_b32 s4, 608256
  buffer_load_dwordx2 v[82:83], v22, s[32:35], s4 offen sc1
  s_mov_b32 s4, 675840
  buffer_load_dwordx2 v[84:85], v22, s[32:35], s4 offen sc1
  s_mov_b32 s4, 743424
  buffer_load_dwordx2 v[86:87], v22, s[32:35], s4 offen sc1
  s_mov_b32 s4, 811008
  buffer_load_dwordx2 v[88:89], v22, s[32:35], s4 offen sc1
  s_mov_b32 s4, 878592
  buffer_load_dwordx2 v[90:91], v22, s[32:35], s4 offen sc1
  s_mov_b32 s4, 946176
  buffer_load_dwordx2 v[92:93], v22, s[32:35], s4 offen sc1
  s_mov_b32 s4, 1013760
  buffer_load_dwordx2 v[94:95], v22, s[32:35], s4 offen sc1
  v_lshrrev_b32 v3, 5, v0
  v_lshlrev_b32 v10, 11, v20
  v_lshl_add_u32 v10, v3, 4, v10
  s_lshl_b32 s4, s24, 1
  v_add_u32 v10, s4, v10
  s_waitcnt vmcnt(16)
  s_branch L_nou2
L_nou:
  s_waitcnt vmcnt(0)
L_nou2:
  s_barrier
  s_mov_b32 s60, 0
  s_mov_b32 s8, 0
  s_mov_b32 s9, 1
  s_mov_b64 exec, 0xffff
  buffer_load_dword v5, v25, s[32:35], 0 offen sc1
  s_mov_b64 exec, -1
  s_waitcnt vmcnt(1)
  s_cmp_ge_u32 s23, 2
  s_cbranch_scc1 L_h0
  v_mfma_f32_32x32x16_bf16 v[128:143], v[64:67], v[96:99], 0
  v_mfma_f32_32x32x16_bf16 v[128:143], v[68:71], v[100:103], v[128:143]
  v_mfma_f32_32x32x16_bf16 v[128:143], v[72:75], v[104:107], v[128:143]
  v_mfma_f32_32x32x16_bf16 v[128:143], v[76:79], v[108:111], v[128:143]
  v_mfma_f32_32x32x16_bf16 v[128:143], v[80:83], v[112:115], v[128:143]
  v_mfma_f32_32x32x16_bf16 v[128:143], v[84:87], v[116:119], v[128:143]
  v_mfma_f32_32x32x16_bf16 v[128:143], v[88:91], v[120:123], v[128:143]
  v_mfma_f32_32x32x16_bf16 v[128:143], v[92:95], v[124:127], v[128:143]
L_h0:
  s_mov_b64 exec, 0xffff
  s_branch L_opw
L_opl:
  buffer_load_dword v5, v25, s[32:35], 0 offen sc1
  s_add_u32 s60, s60, 1
  s_cmp_gt_u32 s60, 200000
  s_cbranch_scc1 L_opx
L_opw:
  s_waitcnt vmcnt(0)
  v_cmp_ne_u32 vcc, s20, v5
  s_and_b32 s4, vcc_lo, 0xff
  s_and_b32 s9, vcc_lo, 0xff00
  s_cmp_lg_u32 s4, 0
  s_cbranch_scc1 L_opl
L_opx:
  s_mov_b64 exec, -1
  s_lshl_b32 s4, s8, 13
  s_add_u32 s4, s4, s30
  s_lshl_b32 s5, s8, 18
  s_add_u32 s5, s5, s13
  s_add_u32 m0, s4, 0
  s_add_u32 s7, s5, 0
  buffer_load_dwordx4 v1, s[32:35], s7 offen sc1 lds
  buffer_load_dwordx4 v1, s[32:35], s7 offen offset:1024 sc1 lds
  s_add_u32 m0, s4, 2048
  s_add_u32 s7, s5, 65536
  buffer_load_dwordx4 v1, s[32:35], s7 offen sc1 lds
  buffer_load_dwordx4 v1, s[32:35], s7 offen offset:1024 sc1 lds
  s_add_u32 m0, s4, 4096
  s_add_u32 s7, s5, 131072
  buffer_load_dwordx4 v1, s[32:35], s7 offen sc1 lds
  buffer_load_dwordx4 v1, s[32:35], s7 offen offset:1024 sc1 lds
  s_add_u32 m0, s4, 6144
  s_add_u32 s7, s5, 196608
  buffer_load_dwordx4 v1, s[32:35], s7 offen sc1 lds
  buffer_load_dwordx4 v1, s[32:35], s7 offen offset:1024 sc1 lds
  s_mov_b32 s8, 1
  s_cmp_lg_u32 s9, 0
  s_cbranch_scc1 L_op2
  s_lshl_b32 s4, s8, 13
  s_add_u32 s4, s4, s30
  s_lshl_b32 s5, s8, 18
  s_add_u32 s5, s5, s13
  s_add_u32 m0, s4, 0
  s_add_u32 s7, s5, 0
  buffer_load_dwordx4 v1, s[32:35], s7 offen sc1 lds
  buffer_load_dwordx4 v1, s[32:35], s7 offen offset:1024 sc1 lds
  s_add_u32 m0, s4, 2048
  s_add_u32 s7, s5, 65536
  buffer_load_dwordx4 v1, s[32:35], s7 offen sc1 lds
  buffer_load_dwordx4 v1, s[32:35], s7 offen offset:1024 sc1 lds
  s_add_u32 m0, s4, 4096
  s_add_u32 s7, s5, 131072
  buffer_load_dwordx4 v1, s[32:35], s7 offen sc1 lds
  buffer_load_dwordx4 v1, s[32:35], s7 offen offset:1024 sc1 lds
  s_add_u32 m0, s4, 6144
  s_add_u32 s7, s5, 196608
  buffer_load_dwordx4 v1, s[32:35], s7 offen sc1 lds
  buffer_load_dwordx4 v1, s[32:35], s7 offen offset:1024 sc1 lds
  s_cmp_ge_u32 s23, 2
  s_cbranch_scc1 L_h1a
  s_mov_b32 s3, 0x80008000
  v_xor_b32 v97, s3, v97
  v_xor_b32 v99, s3, v99
  v_xor_b32 v101, s3, v101
  v_xor_b32 v103, s3, v103
  v_xor_b32 v105, s3, v105
  v_xor_b32 v107, s3, v107
  v_xor_b32 v109, s3, v109
  v_xor_b32 v111, s3, v111
  v_xor_b32 v113, s3, v113
  v_xor_b32 v115, s3, v115
  v_xor_b32 v117, s3, v117
  v_xor_b32 v119, s3, v119
  v_xor_b32 v121, s3, v121
  v_xor_b32 v123, s3, v123
  v_xor_b32 v125, s3, v125
  v_xor_b32 v127, s3, v127
  v_cvt_pk_bf16_f32 v44, v128, v129
  v_cvt_pk_bf16_f32 v45, v130, v131
  v_cvt_pk_bf16_f32 v46, v132, v133
  v_cvt_pk_bf16_f32 v47, v134, v135
  v_cvt_pk_bf16_f32 v48, v136, v137
  v_cvt_pk_bf16_f32 v49, v138, v139
  v_cvt_pk_bf16_f32 v50, v140, v141
  v_cvt_pk_bf16_f32 v51, v142, v143
  v_mfma_f32_32x32x16_bf16 v[144:159], v[64:67], v[96:99], 0
  v_mfma_f32_32x32x16_bf16 v[144:159], v[68:71], v[100:103], v[144:159]
  v_mfma_f32_32x32x16_bf16 v[144:159], v[72:75], v[104:107], v[144:159]
  v_mfma_f32_32x32x16_bf16 v[144:159], v[76:79], v[108:111], v[144:159]
  v_mfma_f32_32x32x16_bf16 v[144:159], v[80:83], v[112:115], v[144:159]
  v_mfma_f32_32x32x16_bf16 v[144:159], v[84:87], v[116:119], v[144:159]
  v_mfma_f32_32x32x16_bf16 v[144:159], v[88:91], v[120:123], v[144:159]
  v_mfma_f32_32x32x16_bf16 v[144:159], v[92:95], v[124:127], v[144:159]
L_h1a:
  s_waitcnt vmcnt(8)
  s_barrier
  s_branch L_op3
L_op2:
  s_lshl_b32 s3, s8, 3
  s_lshl_b32 s10, 0xff, s3
  s_mov_b32 s11, 0
  s_cmp_ge_u32 s23, 2
  s_cbranch_scc1 L_h1b
  s_mov_b32 s3, 0x80008000
  v_xor_b32 v97, s3, v97
  v_xor_b32 v99, s3, v99
  v_xor_b32 v101, s3, v101
  v_xor_b32 v103, s3, v103
  v_xor_b32 v105, s3, v105
  v_xor_b32 v107, s3, v107
  v_xor_b32 v109, s3, v109
  v_xor_b32 v111, s3, v111
  v_xor_b32 v113, s3, v113
  v_xor_b32 v115, s3, v115
  v_xor_b32 v117, s3, v117
  v_xor_b32 v119, s3, v119
  v_xor_b32 v121, s3, v121
  v_xor_b32 v123, s3, v123
  v_xor_b32 v125, s3, v125
  v_xor_b32 v127, s3, v127
  v_cvt_pk_bf16_f32 v44, v128, v129
  v_cvt_pk_bf16_f32 v45, v130, v131
  v_cvt_pk_bf16_f32 v46, v132, v133
  v_cvt_pk_bf16_f32 v47, v134, v135
  v_cvt_pk_bf16_f32 v48, v136, v137
  v_cvt_pk_bf16_f32 v49, v138, v139
  v_cvt_pk_bf16_f32 v50, v140, v141
  v_cvt_pk_bf16_f32 v51, v142, v143
  v_mfma_f32_32x32x16_bf16 v[144:159], v[64:67], v[96:99], 0
  v_mfma_f32_32x32x16_bf16 v[144:159], v[68:71], v[100:103], v[144:159]
  v_mfma_f32_32x32x16_bf16 v[144:159], v[72:75], v[104:107], v[144:159]
  v_mfma_f32_32x32x16_bf16 v[144:159], v[76:79], v[108:111], v[144:159]
  v_mfma_f32_32x32x16_bf16 v[144:159], v[80:83], v[112:115], v[144:159]
  v_mfma_f32_32x32x16_bf16 v[144:159], v[84:87], v[116:119], v[144:159]
  v_mfma_f32_32x32x16_bf16 v[144:159], v[88:91], v[120:123], v[144:159]
  v_mfma_f32_32x32x16_bf16 v[144:159], v[92:95], v[124:127], v[144:159]
L_h1b:
  s_waitcnt vmcnt(0)
  s_barrier
  s_mov_b32 s60, 0
  s_mov_b64 exec, s[10:11]
poll4:
  buffer_load_dword v5, v25, s[32:35], 0 offen sc1
  s_add_u32 s60, s60, 1
  s_cmp_gt_u32 s60, 200000
  s_cbranch_scc1 poll4x
  s_waitcnt vmcnt(0)
  v_cmp_ne_u32 vcc, s20, v5
  s_cbranch_vccnz poll4
poll4x:
  s_mov_b64 exec, -1
  s_lshl_b32 s4, s8, 13
  s_add_u32 s4, s4, s30
  s_lshl_b32 s5, s8, 18
  s_add_u32 s5, s5, s13
  s_add_u32 m0, s4, 0
  s_add_u32 s7, s5, 0
  buffer_load_dwordx4 v1, s[32:35], s7 offen sc1 lds
  buffer_load_dwordx4 v1, s[32:35], s7 offen offset:1024 sc1 lds
  s_add_u32 m0, s4, 2048
  s_add_u32 s7, s5, 65536
  buffer_load_dwordx4 v1, s[32:35], s7 offen sc1 lds
  buffer_load_dwordx4 v1, s[32:35], s7 offen offset:1024 sc1 lds
  s_add_u32 m0, s4, 4096
  s_add_u32 s7, s5, 131072
  buffer_load_dwordx4 v1, s[32:35], s7 offen sc1 lds
  buffer_load_dwordx4 v1, s[32:35], s7 offen offset:1024 sc1 lds
  s_add_u32 m0, s4, 6144
  s_add_u32 s7, s5, 196608
  buffer_load_dwordx4 v1, s[32:35], s7 offen sc1 lds
  buffer_load_dwordx4 v1, s[32:35], s7 offen offset:1024 sc1 lds
L_op3:
  s_waitcnt vmcnt(0)
  s_barrier
  s_cmp_ge_u32 s23, 2
  s_cbranch_scc1 L_h2
  s_mov_b32 s3, 2097152
  buffer_store_dwordx4 v[44:47], v10, s[40:43], 0 offen offset:0
  buffer_store_dwordx4 v[48:51], v10, s[40:43], 0 offen offset:32
  s_nop 7
  v_cvt_pk_bf16_f32 v52, v144, v145
  v_cvt_pk_bf16_f32 v53, v146, v147
  v_cvt_pk_bf16_f32 v54, v148, v149
  v_cvt_pk_bf16_f32 v55, v150, v151
  v_cvt_pk_bf16_f32 v56, v152, v153
  v_cvt_pk_bf16_f32 v57, v154, v155
  v_cvt_pk_bf16_f32 v58, v156, v157
  v_cvt_pk_bf16_f32 v59, v158, v159
  buffer_store_dwordx4 v[52:55], v10, s[40:43], s3 offen offset:0
  buffer_store_dwordx4 v[56:59], v10, s[40:43], s3 offen offset:32
L_h2:
  s_endpgm
L_consumer:
  s_cmp_lg_u32 s19, 7
  s_cbranch_scc1 L_cpf1
  s_getpc_b64 s[4:5]
L_cpf0:
  s_sub_u32 s4, s4, L_cpf0-concat_heads__spectral_fnet__sliding_block__prompt_kernel
  s_subb_u32 s5, s5, 0
  s_lshl_b32 s3, s18, 3
  v_add_u32 v1, s3, v0
  v_lshlrev_b32 v1, 7, v1
  v_cmp_gt_u32 vcc, L_last_insn-concat_heads__spectral_fnet__sliding_block__prompt_kernel, v1
  s_and_b64 exec, vcc, 0xff
  s_cbranch_execz L_cpf2
  v_mov_b32 v3, s5
  v_add_co_u32 v2, vcc, s4, v1
  s_nop 1
  v_addc_co_u32 v3, vcc, 0, v3, vcc
  global_load_dword v166, v[2:3], off
L_cpf2:
  s_mov_b64 exec, -1
L_cpf1:
  v_and_b32 v1, 31, v0
  v_lshrrev_b32 v2, 5, v0
  v_bfe_u32 v3, v0, 1, 3
  v_xor_b32 v3, v3, v2
  v_lshlrev_b32 v4, 7, v1
  s_or_b32 s3, s2, s19
  s_cmp_lg_u32 s3, 4
  s_waitcnt lgkmcnt(0)
  s_mov_b32 s56, s82
  s_mov_b32 s57, s83
  s_mov_b32 s58, 256
  s_mov_b32 s59, 0x20000
  s_cbranch_scc1 L_nonpub
  s_cmp_lg_u32 s2, 0
  s_cbranch_scc1 L_nonpub
  s_memrealtime s[4:5]
  s_waitcnt lgkmcnt(0)
  s_or_b32 s4, s4, 1
  v_mov_b32 v5, s4
  s_mov_b64 exec, 1
  buffer_store_dword v5, off, s[56:59], 0 sc0 sc1
  s_mov_b64 exec, -1
L_nonpub:
  s_mov_b32 s32, s84
  s_mov_b32 s33, s85
  s_mov_b32 s34, 16777216
  s_mov_b32 s35, 0x20000
  s_cmp_lg_u32 s19, 6
  s_cbranch_scc1 L_ptt
  s_lshl_b32 s3, s22, 7
  s_add_u32 s3, s3, 11927552
  buffer_load_dword v166, off, s[32:35], s3
L_ptt:
  s_mov_b32 s40, s80
  s_mov_b32 s41, s81
  s_mov_b32 s42, 4194304
  s_mov_b32 s43, 0x20000
  s_mov_b32 s64, 0xffffffff
  s_mov_b32 s65, 0xfffffff0
  s_mov_b32 s66, 0xfffffffe
  s_mov_b32 s67, 0xffffffe0
  s_mov_b32 s68, 0xfffffffc
  s_mov_b32 s69, 0xffffffc0
  s_mov_b32 s70, 0xfffffff8
  s_mov_b32 s71, 0xffffff80
  s_mov_b32 s72, 0xffffff00
  s_mov_b32 s73, 0xfffff000
  s_mov_b32 s74, 0xfffffe00
  s_mov_b32 s75, 0xffffe000
  s_mov_b32 s76, 0xfffffc00
  s_mov_b32 s77, 0xffffc000
  s_mov_b32 s78, 0xfffff800
  s_mov_b32 s79, 0xffff8000
  s_mov_b32 s80, 0xffff0000
  s_mov_b32 s81, 0xfff00000
  s_mov_b32 s82, 0xfffe0000
  s_mov_b32 s83, 0xffe00000
  s_mov_b32 s84, 0xfffc0000
  s_mov_b32 s85, 0xffc00000
  s_mov_b32 s86, 0xfff80000
  s_mov_b32 s87, 0xff800000
  s_mov_b32 s88, 0xff000000
  s_mov_b32 s89, 0xf0000000
  s_mov_b32 s90, 0xfe000000
  s_mov_b32 s91, 0xe0000000
  s_mov_b32 s92, 0xfc000000
  s_mov_b32 s93, 0xc0000000
  s_mov_b32 s94, 0xf8000000
  s_mov_b32 s95, 0x80000000
  v_xor_b32 v5, 0, v3
  v_lshl_add_u32 v8, v5, 4, v4
  v_xor_b32 v5, 2, v3
  v_lshl_add_u32 v9, v5, 4, v4
  v_xor_b32 v5, 4, v3
  v_lshl_add_u32 v10, v5, 4, v4
  v_xor_b32 v5, 6, v3
  v_lshl_add_u32 v11, v5, 4, v4
  s_getreg_b32 s14, hwreg(HW_REG_XCC_ID, 0, 16)
  s_lshl_b32 s14, s14, 8
  v_bfe_u32 v3, v0, 2, 2
  v_lshl_add_u32 v7, v2, 3, v3
  v_lshlrev_b32 v4, 7, v7
  v_bfe_u32 v5, v0, 4, 1
  v_lshlrev_b32 v5, 1, v5
  v_bfe_u32 v6, v0, 1, 1
  v_add_u32 v5, v5, v6
  s_and_b32 s3, s19, 2
  s_lshl_b32 s3, s3, 1
  v_add_u32 v5, s3, v5
  v_bfe_u32 v6, v0, 3, 1
  v_lshlrev_b32 v6, 2, v6
  v_xor_b32 v5, v5, v6
  v_lshl_add_u32 v4, v5, 4, v4
  v_and_b32 v6, 1, v0
  v_lshl_add_u32 v4, v6, 3, v4
  s_cmp_lt_u32 s19, 4
  s_cbranch_scc1 L_kv
  s_and_b32 s3, s19, 2
  s_lshl_b32 s3, s3, 11
  s_add_u32 s3, s3, 81920
  v_add_u32 v8, s3, v8
  v_add_u32 v9, s3, v9
  v_add_u32 v10, s3, v10
  v_add_u32 v11, s3, v11
  s_and_b32 s24, s19, 1
  s_lshr_b32 s3, s18, 2
  s_and_b32 s25, s3, 6
  s_lshl_b32 s3, s3, 1
  s_add_u32 s6, s3, s24
  s_lshl_b32 s3, s6, 4
  v_and_b32 v5, 15, v0
  v_add_u32 v7, s3, v5
  v_bfe_u32 v6, v0, 4, 1
  v_cvt_f32_u32 v13, v6
  v_mul_f32 v13, 0x3e800000, v13
  s_cmp_eq_u32 s6, 0
  s_cselect_b32 s28, 0x10000, 0
  s_mov_b32 s29, s28
  v_mov_b32 v6, 256
  v_cndmask_b32 v7, v7, v6, s[28:29]
  v_cndmask_b32 v13, v13, 0, s[28:29]
  v_cvt_f32_u32 v12, v7
  v_mul_f32 v12, 0x3b000000, v12
  v_and_b32 v6, 1, v0
  v_lshlrev_b32 v6, 31, v6
  v_or_b32 v14, 1.0, v6
  s_mov_b32 s3, s16
  s_lshr_b32 s4, s6, 1
  s_lshl_b32 s4, s4, 5
  s_add_u32 s4, s4, s3
  s_lshl_b32 s4, s4, 1
  s_add_u32 s4, s4, s24
  s_lshl_b32 s26, s4, 2
  s_mul_i32 s3, s3, 67584
  s_lshl_b32 s4, s6, 8
  s_add_u32 s3, s3, s4
  s_add_u32 s3, s3, 8388608
  v_lshl_add_u32 v5, v5, 4, s3
  v_lshrrev_b32 v6, 4, v0
  s_movk_i32 s4, 4224
  v_mad_u32_u24 v15, v6, s4, v5
  s_lshl_b32 s3, s24, 11
  s_add_u32 s3, s3, 106496
  v_lshl_add_u32 v164, v0, 4, s3
  s_add_u32 s3, s25, 0
  s_and_b32 s3, s3, 7
  s_lshl_b32 s3, s3, 6
  v_lshl_add_u32 v68, v2, 3, s3
  v_cvt_f32_u32 v68, v68
  v_mul_f32 v68, v68, v12
  v_fract_f32 v68, v68
  v_add_f32 v68, v68, v13
  v_add_f32 v69, v68, v12
  v_add_f32 v70, v69, v12
  v_add_f32 v71, v70, v12
  v_add_f32 v72, v71, v12
  v_add_f32 v73, v72, v12
  v_add_f32 v74, v73, v12
  v_add_f32 v75, v74, v12
  v_cos_f32 v76, v68
  v_cos_f32 v77, v69
  v_cos_f32 v78, v70
  v_cos_f32 v79, v71
  v_cos_f32 v80, v72
  v_cos_f32 v81, v73
  v_cos_f32 v82, v74
  v_cos_f32 v83, v75
  v_fmamk_f32 v68, v12, 0x41100000, v75
  v_cvt_pk_bf16_f32 v100, v76, v77
  v_cvt_pk_bf16_f32 v101, v78, v79
  v_cvt_pk_bf16_f32 v102, v80, v81
  v_cvt_pk_bf16_f32 v103, v82, v83
  v_add_f32 v69, v68, v12
  v_add_f32 v70, v69, v12
  v_add_f32 v71, v70, v12
  v_add_f32 v72, v71, v12
  v_add_f32 v73, v72, v12
  v_add_f32 v74, v73, v12
  v_add_f32 v75, v74, v12
  v_cos_f32 v76, v68
  v_cos_f32 v77, v69
  v_cos_f32 v78, v70
  v_cos_f32 v79, v71
  v_cos_f32 v80, v72
  v_cos_f32 v81, v73
  v_cos_f32 v82, v74
  v_cos_f32 v83, v75
  v_fmamk_f32 v68, v12, 0x41100000, v75
  v_cvt_pk_bf16_f32 v104, v76, v77
  v_cvt_pk_bf16_f32 v105, v78, v79
  v_cvt_pk_bf16_f32 v106, v80, v81
  v_cvt_pk_bf16_f32 v107, v82, v83
  v_add_f32 v69, v68, v12
  v_add_f32 v70, v69, v12
  v_add_f32 v71, v70, v12
  v_add_f32 v72, v71, v12
  v_add_f32 v73, v72, v12
  v_add_f32 v74, v73, v12
  v_add_f32 v75, v74, v12
  v_cos_f32 v76, v68
  v_cos_f32 v77, v69
  v_cos_f32 v78, v70
  v_cos_f32 v79, v71
  v_cos_f32 v80, v72
  v_cos_f32 v81, v73
  v_cos_f32 v82, v74
  v_cos_f32 v83, v75
  v_fmamk_f32 v68, v12, 0x41100000, v75
  v_cvt_pk_bf16_f32 v108, v76, v77
  v_cvt_pk_bf16_f32 v109, v78, v79
  v_cvt_pk_bf16_f32 v110, v80, v81
  v_cvt_pk_bf16_f32 v111, v82, v83
  v_add_f32 v69, v68, v12
  v_add_f32 v70, v69, v12
  v_add_f32 v71, v70, v12
  v_add_f32 v72, v71, v12
  v_add_f32 v73, v72, v12
  v_add_f32 v74, v73, v12
  v_add_f32 v75, v74, v12
  v_cos_f32 v76, v68
  v_cos_f32 v77, v69
  v_cos_f32 v78, v70
  v_cos_f32 v79, v71
  v_cos_f32 v80, v72
  v_cos_f32 v81, v73
  v_cos_f32 v82, v74
  v_cos_f32 v83, v75
  v_fmamk_f32 v68, v12, 0x41100000, v75
  v_cvt_pk_bf16_f32 v112, v76, v77
  v_cvt_pk_bf16_f32 v113, v78, v79
  v_cvt_pk_bf16_f32 v114, v80, v81
  v_cvt_pk_bf16_f32 v115, v82, v83
  s_add_u32 s3, s25, 1
  s_and_b32 s3, s3, 7
  s_lshl_b32 s3, s3, 6
  v_lshl_add_u32 v68, v2, 3, s3
  v_cvt_f32_u32 v68, v68
  v_mul_f32 v68, v68, v12
  v_fract_f32 v68, v68
  v_add_f32 v68, v68, v13
  v_add_f32 v69, v68, v12
  v_add_f32 v70, v69, v12
  v_add_f32 v71, v70, v12
  v_add_f32 v72, v71, v12
  v_add_f32 v73, v72, v12
  v_add_f32 v74, v73, v12
  v_add_f32 v75, v74, v12
  v_cos_f32 v76, v68
  v_cos_f32 v77, v69
  v_cos_f32 v78, v70
  v_cos_f32 v79, v71
  v_cos_f32 v80, v72
  v_cos_f32 v81, v73
  v_cos_f32 v82, v74
  v_cos_f32 v83, v75
  v_fmamk_f32 v68, v12, 0x41100000, v75
  v_cvt_pk_bf16_f32 v116, v76, v77
  v_cvt_pk_bf16_f32 v117, v78, v79
  v_cvt_pk_bf16_f32 v118, v80, v81
  v_cvt_pk_bf16_f32 v119, v82, v83
  v_add_f32 v69, v68, v12
  v_add_f32 v70, v69, v12
  v_add_f32 v71, v70, v12
  v_add_f32 v72, v71, v12
  v_add_f32 v73, v72, v12
  v_add_f32 v74, v73, v12
  v_add_f32 v75, v74, v12
  v_cos_f32 v76, v68
  v_cos_f32 v77, v69
  v_cos_f32 v78, v70
  v_cos_f32 v79, v71
  v_cos_f32 v80, v72
  v_cos_f32 v81, v73
  v_cos_f32 v82, v74
  v_cos_f32 v83, v75
  v_fmamk_f32 v68, v12, 0x41100000, v75
  v_cvt_pk_bf16_f32 v120, v76, v77
  v_cvt_pk_bf16_f32 v121, v78, v79
  v_cvt_pk_bf16_f32 v122, v80, v81
  v_cvt_pk_bf16_f32 v123, v82, v83
  v_add_f32 v69, v68, v12
  v_add_f32 v70, v69, v12
  v_add_f32 v71, v70, v12
  v_add_f32 v72, v71, v12
  v_add_f32 v73, v72, v12
  v_add_f32 v74, v73, v12
  v_add_f32 v75, v74, v12
  v_cos_f32 v76, v68
  v_cos_f32 v77, v69
  v_cos_f32 v78, v70
  v_cos_f32 v79, v71
  v_cos_f32 v80, v72
  v_cos_f32 v81, v73
  v_cos_f32 v82, v74
  v_cos_f32 v83, v75
  v_fmamk_f32 v68, v12, 0x41100000, v75
  v_cvt_pk_bf16_f32 v124, v76, v77
  v_cvt_pk_bf16_f32 v125, v78, v79
  v_cvt_pk_bf16_f32 v126, v80, v81
  v_cvt_pk_bf16_f32 v127, v82, v83
  v_add_f32 v69, v68, v12
  v_add_f32 v70, v69, v12
  v_add_f32 v71, v70, v12
  v_add_f32 v72, v71, v12
  v_add_f32 v73, v72, v12
  v_add_f32 v74, v73, v12
  v_add_f32 v75, v74, v12
  v_cos_f32 v76, v68
  v_cos_f32 v77, v69
  v_cos_f32 v78, v70
  v_cos_f32 v79, v71
  v_cos_f32 v80, v72
  v_cos_f32 v81, v73
  v_cos_f32 v82, v74
  v_cos_f32 v83, v75
  v_fmamk_f32 v68, v12, 0x41100000, v75
  v_cvt_pk_bf16_f32 v128, v76, v77
  v_cvt_pk_bf16_f32 v129, v78, v79
  v_cvt_pk_bf16_f32 v130, v80, v81
  v_cvt_pk_bf16_f32 v131, v82, v83
  s_waitcnt lgkmcnt(0)
  s_barrier
  ds_read_b128 v[20:23], v8
  ds_read_b128 v[24:27], v9
  s_waitcnt lgkmcnt(1)
  v_mfma_f32_32x32x16_bf16 v[36:51], v[20:23], v[100:103], 0
  ds_read_b128 v[28:31], v10
  s_add_u32 s3, s25, 2
  s_and_b32 s3, s3, 7
  s_lshl_b32 s3, s3, 6
  v_lshl_add_u32 v68, v2, 3, s3
  v_cvt_f32_u32 v68, v68
  v_mul_f32 v68, v68, v12
  v_fract_f32 v68, v68
  v_add_f32 v68, v68, v13
  v_add_f32 v69, v68, v12
  v_add_f32 v70, v69, v12
  v_add_f32 v71, v70, v12
  v_add_f32 v72, v71, v12
  v_add_f32 v73, v72, v12
  v_add_f32 v74, v73, v12
  v_add_f32 v75, v74, v12
  v_cos_f32 v76, v68
  v_cos_f32 v77, v69
  v_cos_f32 v78, v70
  v_cos_f32 v79, v71
  v_cos_f32 v80, v72
  v_cos_f32 v81, v73
  v_cos_f32 v82, v74
  v_cos_f32 v83, v75
  v_fmamk_f32 v68, v12, 0x41100000, v75
  v_cvt_pk_bf16_f32 v132, v76, v77
  v_cvt_pk_bf16_f32 v133, v78, v79
  v_cvt_pk_bf16_f32 v134, v80, v81
  v_cvt_pk_bf16_f32 v135, v82, v83
  s_waitcnt lgkmcnt(1)
  v_mfma_f32_32x32x16_bf16 v[36:51], v[24:27], v[104:107], v[36:51]
  ds_read_b128 v[32:35], v11
  v_add_f32 v69, v68, v12
  v_add_f32 v70, v69, v12
  v_add_f32 v71, v70, v12
  v_add_f32 v72, v71, v12
  v_add_f32 v73, v72, v12
  v_add_f32 v74, v73, v12
  v_add_f32 v75, v74, v12
  v_cos_f32 v76, v68
  v_cos_f32 v77, v69
  v_cos_f32 v78, v70
  v_cos_f32 v79, v71
  v_cos_f32 v80, v72
  v_cos_f32 v81, v73
  v_cos_f32 v82, v74
  v_cos_f32 v83, v75
  v_fmamk_f32 v68, v12, 0x41100000, v75
  v_cvt_pk_bf16_f32 v136, v76, v77
  v_cvt_pk_bf16_f32 v137, v78, v79
  v_cvt_pk_bf16_f32 v138, v80, v81
  v_cvt_pk_bf16_f32 v139, v82, v83
  s_waitcnt lgkmcnt(1)
  v_mfma_f32_32x32x16_bf16 v[36:51], v[28:31], v[108:111], v[36:51]
  v_add_f32 v69, v68, v12
  v_add_f32 v70, v69, v12
  v_add_f32 v71, v70, v12
  v_add_f32 v72, v71, v12
  v_add_f32 v73, v72, v12
  v_add_f32 v74, v73, v12
  v_add_f32 v75, v74, v12
  v_cos_f32 v76, v68
  v_cos_f32 v77, v69
  v_cos_f32 v78, v70
  v_cos_f32 v79, v71
  v_cos_f32 v80, v72
  v_cos_f32 v81, v73
  v_cos_f32 v82, v74
  v_cos_f32 v83, v75
  v_fmamk_f32 v68, v12, 0x41100000, v75
  v_cvt_pk_bf16_f32 v140, v76, v77
  v_cvt_pk_bf16_f32 v141, v78, v79
  v_cvt_pk_bf16_f32 v142, v80, v81
  v_cvt_pk_bf16_f32 v143, v82, v83
  s_mov_b32 s3, 24576
  v_add_u32 v8, s3, v8
  v_add_u32 v9, s3, v9
  v_add_u32 v10, s3, v10
  v_add_u32 v11, s3, v11
  s_waitcnt lgkmcnt(0)
  s_barrier
  ds_read_b128 v[20:23], v8
  v_mfma_f32_32x32x16_bf16 v[36:51], v[32:35], v[112:115], v[36:51]
  ds_read_b128 v[24:27], v9
  v_add_f32 v69, v68, v12
  v_add_f32 v70, v69, v12
  v_add_f32 v71, v70, v12
  v_add_f32 v72, v71, v12
  v_add_f32 v73, v72, v12
  v_add_f32 v74, v73, v12
  v_add_f32 v75, v74, v12
  v_cos_f32 v76, v68
  v_cos_f32 v77, v69
  v_cos_f32 v78, v70
  v_cos_f32 v79, v71
  v_cos_f32 v80, v72
  v_cos_f32 v81, v73
  v_cos_f32 v82, v74
  v_cos_f32 v83, v75
  v_fmamk_f32 v68, v12, 0x41100000, v75
  v_cvt_pk_bf16_f32 v144, v76, v77
  v_cvt_pk_bf16_f32 v145, v78, v79
  v_cvt_pk_bf16_f32 v146, v80, v81
  v_cvt_pk_bf16_f32 v147, v82, v83
  s_waitcnt lgkmcnt(1)
  v_mfma_f32_32x32x16_bf16 v[36:51], v[20:23], v[116:119], v[36:51]
  ds_read_b128 v[28:31], v10
  s_add_u32 s3, s25, 3
  s_and_b32 s3, s3, 7
  s_lshl_b32 s3, s3, 6
  v_lshl_add_u32 v68, v2, 3, s3
  v_cvt_f32_u32 v68, v68
  v_mul_f32 v68, v68, v12
  v_fract_f32 v68, v68
  v_add_f32 v68, v68, v13
  v_add_f32 v69, v68, v12
  v_add_f32 v70, v69, v12
  v_add_f32 v71, v70, v12
  v_add_f32 v72, v71, v12
  v_add_f32 v73, v72, v12
  v_add_f32 v74, v73, v12
  v_add_f32 v75, v74, v12
  v_cos_f32 v76, v68
  v_cos_f32 v77, v69
  v_cos_f32 v78, v70
  v_cos_f32 v79, v71
  v_cos_f32 v80, v72
  v_cos_f32 v81, v73
  v_cos_f32 v82, v74
  v_cos_f32 v83, v75
  v_fmamk_f32 v68, v12, 0x41100000, v75
  v_cvt_pk_bf16_f32 v148, v76, v77
  v_cvt_pk_bf16_f32 v149, v78, v79
  v_cvt_pk_bf16_f32 v150, v80, v81
  v_cvt_pk_bf16_f32 v151, v82, v83
  s_waitcnt lgkmcnt(1)
  v_mfma_f32_32x32x16_bf16 v[36:51], v[24:27], v[120:123], v[36:51]
  ds_read_b128 v[32:35], v11
  v_add_f32 v69, v68, v12
  v_add_f32 v70, v69, v12
  v_add_f32 v71, v70, v12
  v_add_f32 v72, v71, v12
  v_add_f32 v73, v72, v12
  v_add_f32 v74, v73, v12
  v_add_f32 v75, v74, v12
  v_cos_f32 v76, v68
  v_cos_f32 v77, v69
  v_cos_f32 v78, v70
  v_cos_f32 v79, v71
  v_cos_f32 v80, v72
  v_cos_f32 v81, v73
  v_cos_f32 v82, v74
  v_cos_f32 v83, v75
  v_fmamk_f32 v68, v12, 0x41100000, v75
  v_cvt_pk_bf16_f32 v152, v76, v77
  v_cvt_pk_bf16_f32 v153, v78, v79
  v_cvt_pk_bf16_f32 v154, v80, v81
  v_cvt_pk_bf16_f32 v155, v82, v83
  s_waitcnt lgkmcnt(1)
  v_mfma_f32_32x32x16_bf16 v[36:51], v[28:31], v[124:127], v[36:51]
  v_add_f32 v69, v68, v12
  v_add_f32 v70, v69, v12
  v_add_f32 v71, v70, v12
  v_add_f32 v72, v71, v12
  v_add_f32 v73, v72, v12
  v_add_f32 v74, v73, v12
  v_add_f32 v75, v74, v12
  v_cos_f32 v76, v68
  v_cos_f32 v77, v69
  v_cos_f32 v78, v70
  v_cos_f32 v79, v71
  v_cos_f32 v80, v72
  v_cos_f32 v81, v73
  v_cos_f32 v82, v74
  v_cos_f32 v83, v75
  v_fmamk_f32 v68, v12, 0x41100000, v75
  v_cvt_pk_bf16_f32 v156, v76, v77
  v_cvt_pk_bf16_f32 v157, v78, v79
  v_cvt_pk_bf16_f32 v158, v80, v81
  v_cvt_pk_bf16_f32 v159, v82, v83
  s_mov_b32 s3, 24576
  v_add_u32 v8, s3, v8
  v_add_u32 v9, s3, v9
  v_add_u32 v10, s3, v10
  v_add_u32 v11, s3, v11
  s_waitcnt lgkmcnt(0)
  s_barrier
  ds_read_b128 v[20:23], v8
  v_mfma_f32_32x32x16_bf16 v[36:51], v[32:35], v[128:131], v[36:51]
  ds_read_b128 v[24:27], v9
  v_add_f32 v69, v68, v12
  v_add_f32 v70, v69, v12
  v_add_f32 v71, v70, v12
  v_add_f32 v72, v71, v12
  v_add_f32 v73, v72, v12
  v_add_f32 v74, v73, v12
  v_add_f32 v75, v74, v12
  v_cos_f32 v76, v68
  v_cos_f32 v77, v69
  v_cos_f32 v78, v70
  v_cos_f32 v79, v71
  v_cos_f32 v80, v72
  v_cos_f32 v81, v73
  v_cos_f32 v82, v74
  v_cos_f32 v83, v75
  v_fmamk_f32 v68, v12, 0x41100000, v75
  v_cvt_pk_bf16_f32 v160, v76, v77
  v_cvt_pk_bf16_f32 v161, v78, v79
  v_cvt_pk_bf16_f32 v162, v80, v81
  v_cvt_pk_bf16_f32 v163, v82, v83
  v_lshlrev_b32 v13, 2, v2
  v_mul_u32_u24 v13, v13, v1
  s_waitcnt lgkmcnt(1)
  v_mfma_f32_32x32x16_bf16 v[36:51], v[20:23], v[132:135], v[36:51]
  ds_read_b128 v[28:31], v10
  s_cmp_ge_u32 s19, 6
  s_cbranch_scc1 e5a
  v_mad_u32_u24 v68, v1, 0, v13
  v_and_b32 v68, 31, v68
  v_cvt_f32_u32 v68, v68
  v_mul_f32 v68, 0x3d000000, v68
  v_mad_u32_u24 v69, v1, 1, v13
  v_and_b32 v69, 31, v69
  v_cvt_f32_u32 v69, v69
  v_mul_f32 v69, 0x3d000000, v69
  v_mad_u32_u24 v70, v1, 2, v13
  v_and_b32 v70, 31, v70
  v_cvt_f32_u32 v70, v70
  v_mul_f32 v70, 0x3d000000, v70
  v_mad_u32_u24 v71, v1, 3, v13
  v_and_b32 v71, 31, v71
  v_cvt_f32_u32 v71, v71
  v_mul_f32 v71, 0x3d000000, v71
  s_branch e5b
e5a:
  s_lshl_b32 s6, s22, 1
  s_and_b32 s4, s18, 1
  s_add_u32 s6, s6, s4
  s_lshr_b32 s7, s18, 1
  s_lshl_b32 s10, s7, 5
  s_lshr_b32 s4, s6, 2
  s_lshl_b32 s4, s4, 3
  s_and_b32 s5, s6, 3
  s_add_u32 s4, s4, s5
  s_and_b32 s5, s19, 1
  s_lshl_b32 s5, s5, 2
  s_add_u32 s5, s4, s5
  s_sub_u32 s4, 32, s5
  s_and_b32 s4, s4, 31
  s_cmp_lt_u32 s2, 128
  s_cselect_b32 s11, s5, s4
  s_cselect_b64 vcc, -1, 0
  v_and_b32 v69, 31, v0
  v_lshl_add_u32 v68, v69, 5, s11
  v_lshrrev_b32 v71, 5, v0
  v_sub_u32 v70, 2048, v68
  v_cndmask_b32 v70, v70, v68, vcc
  v_cvt_f32_u32 v70, v70
  v_mul_f32 v17, 0x3a000000, v70
  v_lshlrev_b32 v70, 5, v71
  v_cvt_f32_u32 v70, v70
  v_mul_f32 v18, v17, v70
e5b:
  s_waitcnt lgkmcnt(1)
  v_mfma_f32_32x32x16_bf16 v[36:51], v[24:27], v[136:139], v[36:51]
  ds_read_b128 v[32:35], v11
  s_cmp_ge_u32 s19, 6
  s_cbranch_scc1 e6a
  v_mad_u32_u24 v72, v1, 8, v13
  v_and_b32 v72, 31, v72
  v_cvt_f32_u32 v72, v72
  v_mul_f32 v72, 0x3d000000, v72
  v_mad_u32_u24 v73, v1, 9, v13
  v_and_b32 v73, 31, v73
  v_cvt_f32_u32 v73, v73
  v_mul_f32 v73, 0x3d000000, v73
  v_mad_u32_u24 v74, v1, 10, v13
  v_and_b32 v74, 31, v74
  v_cvt_f32_u32 v74, v74
  v_mul_f32 v74, 0x3d000000, v74
  v_mad_u32_u24 v75, v1, 11, v13
  v_and_b32 v75, 31, v75
  v_cvt_f32_u32 v75, v75
  v_mul_f32 v75, 0x3d000000, v75
  s_branch e6b
e6a:
  v_add_f32 v68, v18, v17
  v_add_f32 v69, v68, v17
  v_add_f32 v70, v69, v17
  v_cos_f32 v72, v18
  v_cos_f32 v73, v68
  v_cos_f32 v74, v69
  v_cos_f32 v75, v70
  v_sin_f32 v76, v18
  v_sin_f32 v77, v68
  v_sin_f32 v78, v69
  v_sin_f32 v79, v70
  v_add_f32 v18, v70, v17
  v_cvt_pk_bf16_f32 v84, v72, v76
  v_cvt_pk_bf16_f32 v85, v73, v77
  v_cvt_pk_bf16_f32 v86, v74, v78
  v_cvt_pk_bf16_f32 v87, v75, v79
e6b:
  s_waitcnt lgkmcnt(1)
  v_mfma_f32_32x32x16_bf16 v[36:51], v[28:31], v[140:143], v[36:51]
  s_cmp_ge_u32 s19, 6
  s_cbranch_scc1 e7a
  v_cos_f32 v76, v68
  v_cos_f32 v77, v69
  v_cos_f32 v78, v70
  v_cos_f32 v79, v71
  v_cos_f32 v80, v72
  v_cos_f32 v81, v73
  v_cos_f32 v82, v74
  v_cos_f32 v83, v75
  v_sin_f32 v68, v68
  v_sin_f32 v69, v69
  v_sin_f32 v70, v70
  v_sin_f32 v71, v71
  v_sin_f32 v72, v72
  v_sin_f32 v73, v73
  v_sin_f32 v74, v74
  v_sin_f32 v75, v75
  s_nop 0
  s_branch e7b
e7a:
  v_add_f32 v68, v18, v17
  v_add_f32 v69, v68, v17
  v_add_f32 v70, v69, v17
  v_cos_f32 v72, v18
  v_cos_f32 v73, v68
  v_cos_f32 v74, v69
  v_cos_f32 v75, v70
  v_sin_f32 v76, v18
  v_sin_f32 v77, v68
  v_sin_f32 v78, v69
  v_sin_f32 v79, v70
  v_add_f32 v18, v70, v17
  v_cvt_pk_bf16_f32 v88, v72, v76
  v_cvt_pk_bf16_f32 v89, v73, v77
  v_cvt_pk_bf16_f32 v90, v74, v78
  v_cvt_pk_bf16_f32 v91, v75, v79
e7b:
  s_mov_b32 s3, -49152
  v_add_u32 v8, s3, v8
  v_add_u32 v9, s3, v9
  v_add_u32 v10, s3, v10
  v_add_u32 v11, s3, v11
  s_waitcnt lgkmcnt(0)
  s_barrier
  ds_read_b128 v[20:23], v8
  v_mfma_f32_32x32x16_bf16 v[36:51], v[32:35], v[144:147], v[36:51]
  ds_read_b128 v[24:27], v9
  s_cmp_ge_u32 s19, 6
  s_cbranch_scc1 e8a
  v_cvt_pk_bf16_f32 v84, v76, v77
  v_cvt_pk_bf16_f32 v92, -v68, -v69
  v_cvt_pk_bf16_f32 v4, v68, v69
  v_cvt_pk_bf16_f32 v85, v78, v79
  v_cvt_pk_bf16_f32 v93, -v70, -v71
  v_cvt_pk_bf16_f32 v5, v70, v71
  v_cvt_pk_bf16_f32 v86, v80, v81
  v_cvt_pk_bf16_f32 v94, -v72, -v73
  v_cvt_pk_bf16_f32 v6, v72, v73
  v_cvt_pk_bf16_f32 v87, v82, v83
  v_cvt_pk_bf16_f32 v95, -v74, -v75
  v_cvt_pk_bf16_f32 v7, v74, v75
  s_branch e8b
e8a:
e8b:
  s_waitcnt lgkmcnt(1)
  v_mfma_f32_32x32x16_bf16 v[36:51], v[20:23], v[148:151], v[36:51]
  ds_read_b128 v[28:31], v10
  s_cmp_ge_u32 s19, 6
  s_cbranch_scc1 e9a
  v_mad_u32_u24 v68, v1, 16, v13
  v_and_b32 v68, 31, v68
  v_cvt_f32_u32 v68, v68
  v_mul_f32 v68, 0x3d000000, v68
  v_mad_u32_u24 v69, v1, 17, v13
  v_and_b32 v69, 31, v69
  v_cvt_f32_u32 v69, v69
  v_mul_f32 v69, 0x3d000000, v69
  v_mad_u32_u24 v70, v1, 18, v13
  v_and_b32 v70, 31, v70
  v_cvt_f32_u32 v70, v70
  v_mul_f32 v70, 0x3d000000, v70
  v_mad_u32_u24 v71, v1, 19, v13
  v_and_b32 v71, 31, v71
  v_cvt_f32_u32 v71, v71
  v_mul_f32 v71, 0x3d000000, v71
  s_branch e9b
e9a:
  v_add_f32 v68, v18, v17
  v_add_f32 v69, v68, v17
  v_add_f32 v70, v69, v17
  v_cos_f32 v72, v18
  v_cos_f32 v73, v68
  v_cos_f32 v74, v69
  v_cos_f32 v75, v70
  v_sin_f32 v76, v18
  v_sin_f32 v77, v68
  v_sin_f32 v78, v69
  v_sin_f32 v79, v70
  v_add_f32 v18, v70, v17
  v_cvt_pk_bf16_f32 v92, v72, v76
  v_cvt_pk_bf16_f32 v93, v73, v77
  v_cvt_pk_bf16_f32 v94, v74, v78
  v_cvt_pk_bf16_f32 v95, v75, v79
e9b:
  s_waitcnt lgkmcnt(1)
  v_mfma_f32_32x32x16_bf16 v[36:51], v[24:27], v[152:155], v[36:51]
  ds_read_b128 v[32:35], v11
  s_cmp_ge_u32 s19, 6
  s_cbranch_scc1 e10a
  v_mad_u32_u24 v72, v1, 24, v13
  v_and_b32 v72, 31, v72
  v_cvt_f32_u32 v72, v72
  v_mul_f32 v72, 0x3d000000, v72
  v_mad_u32_u24 v73, v1, 25, v13
  v_and_b32 v73, 31, v73
  v_cvt_f32_u32 v73, v73
  v_mul_f32 v73, 0x3d000000, v73
  v_mad_u32_u24 v74, v1, 26, v13
  v_and_b32 v74, 31, v74
  v_cvt_f32_u32 v74, v74
  v_mul_f32 v74, 0x3d000000, v74
  v_mad_u32_u24 v75, v1, 27, v13
  v_and_b32 v75, 31, v75
  v_cvt_f32_u32 v75, v75
  v_mul_f32 v75, 0x3d000000, v75
  s_branch e10b
e10a:
  v_add_f32 v68, v18, v17
  v_add_f32 v69, v68, v17
  v_add_f32 v70, v69, v17
  v_cos_f32 v72, v18
  v_cos_f32 v73, v68
  v_cos_f32 v74, v69
  v_cos_f32 v75, v70
  v_sin_f32 v76, v18
  v_sin_f32 v77, v68
  v_sin_f32 v78, v69
  v_sin_f32 v79, v70
  v_add_f32 v18, v70, v17
  v_cvt_pk_bf16_f32 v96, v72, v76
  v_cvt_pk_bf16_f32 v97, v73, v77
  v_cvt_pk_bf16_f32 v98, v74, v78
  v_cvt_pk_bf16_f32 v99, v75, v79
e10b:
  s_waitcnt lgkmcnt(1)
  v_mfma_f32_32x32x16_bf16 v[36:51], v[28:31], v[156:159], v[36:51]
  s_cmp_ge_u32 s19, 6
  s_cbranch_scc1 e11a
  v_cos_f32 v76, v68
  v_cos_f32 v77, v69
  v_cos_f32 v78, v70
  v_cos_f32 v79, v71
  v_cos_f32 v80, v72
  v_cos_f32 v81, v73
  v_cos_f32 v82, v74
  v_cos_f32 v83, v75
  v_sin_f32 v68, v68
  v_sin_f32 v69, v69
  v_sin_f32 v70, v70
  v_sin_f32 v71, v71
  v_sin_f32 v72, v72
  v_sin_f32 v73, v73
  v_sin_f32 v74, v74
  v_sin_f32 v75, v75
  s_nop 0
  s_branch e11b
e11a:
e11b:
  s_mov_b32 s3, 24576
  v_add_u32 v8, s3, v8
  v_add_u32 v9, s3, v9
  v_add_u32 v10, s3, v10
  v_add_u32 v11, s3, v11
  s_waitcnt lgkmcnt(0)
  s_barrier
  ds_read_b128 v[20:23], v8
  v_mfma_f32_32x32x16_bf16 v[36:51], v[32:35], v[160:163], v[36:51]
  ds_read_b128 v[24:27], v9
  s_cmp_ge_u32 s19, 6
  s_cbranch_scc1 e12a
  v_cvt_pk_bf16_f32 v88, v76, v77
  v_cvt_pk_bf16_f32 v96, -v68, -v69
  v_cvt_pk_bf16_f32 v16, v68, v69
  v_cvt_pk_bf16_f32 v89, v78, v79
  v_cvt_pk_bf16_f32 v97, -v70, -v71
  v_cvt_pk_bf16_f32 v17, v70, v71
  v_cvt_pk_bf16_f32 v90, v80, v81
  v_cvt_pk_bf16_f32 v98, -v72, -v73
  v_cvt_pk_bf16_f32 v18, v72, v73
  v_cvt_pk_bf16_f32 v91, v82, v83
  v_cvt_pk_bf16_f32 v99, -v74, -v75
  v_cvt_pk_bf16_f32 v19, v74, v75
  s_branch e12b
e12a:
e12b:
  s_waitcnt lgkmcnt(1)
  v_mfma_f32_32x32x16_bf16 v[52:67], v[20:23], v[100:103], 0
  ds_read_b128 v[28:31], v10
  s_waitcnt lgkmcnt(1)
  v_mfma_f32_32x32x16_bf16 v[52:67], v[24:27], v[104:107], v[52:67]
  ds_read_b128 v[32:35], v11
  s_waitcnt lgkmcnt(1)
  v_mfma_f32_32x32x16_bf16 v[52:67], v[28:31], v[108:111], v[52:67]
  s_mov_b32 s3, 24576
  v_add_u32 v8, s3, v8
  v_add_u32 v9, s3, v9
  v_add_u32 v10, s3, v10
  v_add_u32 v11, s3, v11
  s_waitcnt lgkmcnt(0)
  s_barrier
  ds_read_b128 v[20:23], v8
  v_mfma_f32_32x32x16_bf16 v[52:67], v[32:35], v[112:115], v[52:67]
  ds_read_b128 v[24:27], v9
  s_waitcnt lgkmcnt(1)
  v_mfma_f32_32x32x16_bf16 v[52:67], v[20:23], v[116:119], v[52:67]
  ds_read_b128 v[28:31], v10
  s_waitcnt lgkmcnt(1)
  v_mfma_f32_32x32x16_bf16 v[52:67], v[24:27], v[120:123], v[52:67]
  ds_read_b128 v[32:35], v11
  s_waitcnt lgkmcnt(1)
  v_mfma_f32_32x32x16_bf16 v[52:67], v[28:31], v[124:127], v[52:67]
  s_mov_b32 s3, -49152
  v_add_u32 v8, s3, v8
  v_add_u32 v9, s3, v9
  v_add_u32 v10, s3, v10
  v_add_u32 v11, s3, v11
  s_waitcnt lgkmcnt(0)
  s_barrier
  ds_read_b128 v[20:23], v8
  v_mfma_f32_32x32x16_bf16 v[52:67], v[32:35], v[128:131], v[52:67]
  ds_read_b128 v[24:27], v9
  s_waitcnt lgkmcnt(1)
  v_mfma_f32_32x32x16_bf16 v[52:67], v[20:23], v[132:135], v[52:67]
  ds_read_b128 v[28:31], v10
  s_waitcnt lgkmcnt(1)
  v_mfma_f32_32x32x16_bf16 v[52:67], v[24:27], v[136:139], v[52:67]
  ds_read_b128 v[32:35], v11
  s_waitcnt lgkmcnt(1)
  v_mfma_f32_32x32x16_bf16 v[52:67], v[28:31], v[140:143], v[52:67]
  s_mov_b32 s3, 24576
  v_add_u32 v8, s3, v8
  v_add_u32 v9, s3, v9
  v_add_u32 v10, s3, v10
  v_add_u32 v11, s3, v11
  s_waitcnt lgkmcnt(0)
  s_barrier
  ds_read_b128 v[20:23], v8
  v_mfma_f32_32x32x16_bf16 v[52:67], v[32:35], v[144:147], v[52:67]
  ds_read_b128 v[24:27], v9
  s_waitcnt lgkmcnt(1)
  v_mfma_f32_32x32x16_bf16 v[52:67], v[20:23], v[148:151], v[52:67]
  ds_read_b128 v[28:31], v10
  s_waitcnt lgkmcnt(1)
  v_mfma_f32_32x32x16_bf16 v[52:67], v[24:27], v[152:155], v[52:67]
  ds_read_b128 v[32:35], v11
  s_waitcnt lgkmcnt(1)
  v_mfma_f32_32x32x16_bf16 v[52:67], v[28:31], v[156:159], v[52:67]
  s_waitcnt lgkmcnt(0)
  v_mfma_f32_32x32x16_bf16 v[52:67], v[32:35], v[160:163], v[52:67]
  s_nop 11
  v_fma_f32 v36, v52, v14, v36
  v_fma_f32 v37, v53, v14, v37
  v_fma_f32 v38, v54, v14, v38
  v_fma_f32 v39, v55, v14, v39
  v_fma_f32 v40, v56, v14, v40
  v_fma_f32 v41, v57, v14, v41
  v_fma_f32 v42, v58, v14, v42
  v_fma_f32 v43, v59, v14, v43
  v_fma_f32 v44, v60, v14, v44
  v_fma_f32 v45, v61, v14, v45
  v_fma_f32 v46, v62, v14, v46
  v_fma_f32 v47, v63, v14, v47
  v_fma_f32 v48, v64, v14, v48
  v_fma_f32 v49, v65, v14, v49
  v_fma_f32 v50, v66, v14, v50
  v_fma_f32 v51, v67, v14, v51
  v_cvt_pk_bf16_f32 v20, v36, v37
  v_cvt_pk_bf16_f32 v21, v38, v39
  v_cvt_pk_bf16_f32 v22, v40, v41
  v_cvt_pk_bf16_f32 v23, v42, v43
  v_cvt_pk_bf16_f32 v24, v44, v45
  v_cvt_pk_bf16_f32 v25, v46, v47
  v_cvt_pk_bf16_f32 v26, v48, v49
  v_cvt_pk_bf16_f32 v27, v50, v51
  s_barrier
  s_cmp_lt_u32 s19, 6
  s_cbranch_scc1 L_a1e
  ds_write_b128 v164, v[20:23]
  ds_write_b128 v164, v[24:27] offset:1024
  v_mov_b32 v68, 0
  v_mov_b32 v69, 0
  v_mov_b32 v70, 0
  v_mov_b32 v71, 0
  v_mov_b32 v72, 110592
  ds_write_b128 v72, v[68:71]
  s_lshl_b32 s3, s24, 2
  s_add_u32 s3, s3, 162832
  v_mov_b32 v74, s3
  v_mov_b32 v75, 1
  s_waitcnt lgkmcnt(0)
  ds_write_b32 v74, v75
  v_add_f32 v68, v18, v17
  v_add_f32 v69, v68, v17
  v_add_f32 v70, v69, v17
  v_cos_f32 v72, v18
  v_cos_f32 v73, v68
  v_cos_f32 v74, v69
  v_cos_f32 v75, v70
  v_sin_f32 v76, v18
  v_sin_f32 v77, v68
  v_sin_f32 v78, v69
  v_sin_f32 v79, v70
  v_add_f32 v18, v70, v17
  v_cvt_pk_bf16_f32 v100, v72, v76
  v_cvt_pk_bf16_f32 v101, v73, v77
  v_cvt_pk_bf16_f32 v102, v74, v78
  v_cvt_pk_bf16_f32 v103, v75, v79
  v_add_f32 v68, v18, v17
  v_add_f32 v69, v68, v17
  v_add_f32 v70, v69, v17
  v_cos_f32 v72, v18
  v_cos_f32 v73, v68
  v_cos_f32 v74, v69
  v_cos_f32 v75, v70
  v_sin_f32 v76, v18
  v_sin_f32 v77, v68
  v_sin_f32 v78, v69
  v_sin_f32 v79, v70
  v_add_f32 v18, v70, v17
  v_cvt_pk_bf16_f32 v104, v72, v76
  v_cvt_pk_bf16_f32 v105, v73, v77
  v_cvt_pk_bf16_f32 v106, v74, v78
  v_cvt_pk_bf16_f32 v107, v75, v79
  v_add_f32 v68, v18, v17
  v_add_f32 v69, v68, v17
  v_add_f32 v70, v69, v17
  v_cos_f32 v72, v18
  v_cos_f32 v73, v68
  v_cos_f32 v74, v69
  v_cos_f32 v75, v70
  v_sin_f32 v76, v18
  v_sin_f32 v77, v68
  v_sin_f32 v78, v69
  v_sin_f32 v79, v70
  v_add_f32 v18, v70, v17
  v_cvt_pk_bf16_f32 v108, v72, v76
  v_cvt_pk_bf16_f32 v109, v73, v77
  v_cvt_pk_bf16_f32 v110, v74, v78
  v_cvt_pk_bf16_f32 v111, v75, v79
  v_add_f32 v68, v18, v17
  v_add_f32 v69, v68, v17
  v_add_f32 v70, v69, v17
  v_cos_f32 v72, v18
  v_cos_f32 v73, v68
  v_cos_f32 v74, v69
  v_cos_f32 v75, v70
  v_sin_f32 v76, v18
  v_sin_f32 v77, v68
  v_sin_f32 v78, v69
  v_sin_f32 v79, v70
  v_add_f32 v18, v70, v17
  v_cvt_pk_bf16_f32 v112, v72, v76
  v_cvt_pk_bf16_f32 v113, v73, v77
  v_cvt_pk_bf16_f32 v114, v74, v78
  v_cvt_pk_bf16_f32 v115, v75, v79
  s_barrier
  s_and_b32 s3, s19, 1
  s_lshl_b32 s3, s3, 13
  s_add_u32 s3, s3, 114688
  v_lshl_add_u32 v42, v0, 4, s3
  ds_write_b128 v42, v[84:87] offset:0
  ds_write_b128 v42, v[88:91] offset:1024
  ds_write_b128 v42, v[92:95] offset:2048
  ds_write_b128 v42, v[96:99] offset:3072
  ds_write_b128 v42, v[100:103] offset:4096
  ds_write_b128 v42, v[104:107] offset:5120
  ds_write_b128 v42, v[108:111] offset:6144
  ds_write_b128 v42, v[112:115] offset:7168
  s_barrier
  s_waitcnt lgkmcnt(0)
  s_barrier
  s_barrier
  s_branch L_att
L_a1e:
  s_lshl_b32 s3, s24, 2
  s_add_u32 s3, s3, 162832
  v_mov_b32 v68, s3
  s_mov_b32 s60, 0
L_xw:
  ds_read_b32 v69, v68
  s_add_u32 s60, s60, 1
  s_cmp_gt_u32 s60, 1600000
  s_cbranch_scc1 L_xwx
  s_waitcnt lgkmcnt(0)
  v_cmp_eq_u32 vcc, 0, v69
  s_cbranch_vccnz L_xw
L_xwx:
  ds_read_b128 v[28:31], v164
  ds_read_b128 v[32:35], v164 offset:1024
  s_waitcnt lgkmcnt(0)
  v_permlane16_swap_b32 v20, v28
  v_permlane16_swap_b32 v21, v29
  v_permlane16_swap_b32 v22, v30
  v_permlane16_swap_b32 v23, v31
  v_permlane16_swap_b32 v24, v32
  v_permlane16_swap_b32 v25, v33
  v_permlane16_swap_b32 v26, v34
  v_permlane16_swap_b32 v27, v35
  s_mov_b32 s6, 0x00010001
  s_mov_b32 s7, 0x00010001
  s_cmp_eq_u32 s28, 0
  s_cbranch_scc1 L_nosp1
  v_mov_b32 v124, v28
  v_cndmask_b32 v28, v28, 0, s[6:7]
  v_mov_b32 v125, v29
  v_cndmask_b32 v29, v29, 0, s[6:7]
  v_mov_b32 v126, v30
  v_cndmask_b32 v30, v30, 0, s[6:7]
  v_mov_b32 v127, v31
  v_cndmask_b32 v31, v31, 0, s[6:7]
  v_mov_b32 v128, v32
  v_cndmask_b32 v32, v32, 0, s[6:7]
  v_mov_b32 v129, v33
  v_cndmask_b32 v33, v33, 0, s[6:7]
  v_mov_b32 v130, v34
  v_cndmask_b32 v34, v34, 0, s[6:7]
  v_mov_b32 v131, v35
  v_cndmask_b32 v35, v35, 0, s[6:7]
L_nosp1:
  s_nop 1
  v_mfma_f32_32x32x16_bf16 v[132:147], v[84:87], v[20:23], 0
  v_mfma_f32_32x32x16_bf16 v[148:163], v[92:95], v[20:23], 0
  v_mfma_f32_32x32x16_bf16 v[132:147], v[88:91], v[24:27], v[132:147]
  v_mfma_f32_32x32x16_bf16 v[148:163], v[96:99], v[24:27], v[148:163]
  v_mfma_f32_32x32x16_bf16 v[132:147], v[4:7], v[28:31], v[132:147]
  v_mfma_f32_32x32x16_bf16 v[148:163], v[84:87], v[28:31], v[148:163]
  v_mfma_f32_32x32x16_bf16 v[132:147], v[16:19], v[32:35], v[132:147]
  v_mfma_f32_32x32x16_bf16 v[148:163], v[88:91], v[32:35], v[148:163]
  s_nop 11
  v_cvt_pk_bf16_f32 v36, v132, v148
  v_cvt_pk_bf16_f32 v37, v133, v149
  v_cvt_pk_bf16_f32 v38, v134, v150
  v_cvt_pk_bf16_f32 v39, v135, v151
  v_cvt_pk_bf16_f32 v40, v136, v152
  v_cvt_pk_bf16_f32 v41, v137, v153
  v_cvt_pk_bf16_f32 v42, v138, v154
  v_cvt_pk_bf16_f32 v43, v139, v155
  v_cvt_pk_bf16_f32 v44, v140, v156
  v_cvt_pk_bf16_f32 v45, v141, v157
  v_cvt_pk_bf16_f32 v46, v142, v158
  v_cvt_pk_bf16_f32 v47, v143, v159
  v_cvt_pk_bf16_f32 v48, v144, v160
  v_cvt_pk_bf16_f32 v49, v145, v161
  v_cvt_pk_bf16_f32 v50, v146, v162
  v_cvt_pk_bf16_f32 v51, v147, v163
  v_permlane32_swap_b32 v36, v38
  v_permlane32_swap_b32 v37, v39
  v_permlane32_swap_b32 v40, v42
  v_permlane32_swap_b32 v41, v43
  v_permlane32_swap_b32 v44, v46
  v_permlane32_swap_b32 v45, v47
  v_permlane32_swap_b32 v48, v50
  v_permlane32_swap_b32 v49, v51
  v_permlane16_swap_b32 v36, v37
  v_permlane16_swap_b32 v38, v39
  v_permlane16_swap_b32 v40, v41
  v_permlane16_swap_b32 v42, v43
  v_permlane16_swap_b32 v44, v45
  v_permlane16_swap_b32 v46, v47
  v_permlane16_swap_b32 v48, v49
  v_permlane16_swap_b32 v50, v51
  s_cmp_eq_u32 s28, 0
  s_cbranch_scc1 L_nosp2
  v_mfma_f32_32x32x16_bf16 v[132:147], v[84:87], v[124:127], 0
  v_mfma_f32_32x32x16_bf16 v[148:163], v[92:95], v[124:127], 0
  v_mfma_f32_32x32x16_bf16 v[132:147], v[88:91], v[128:131], v[132:147]
  v_mfma_f32_32x32x16_bf16 v[148:163], v[96:99], v[128:131], v[148:163]
  s_nop 11
  v_cvt_pk_bf16_f32 v52, v132, v148
  v_cvt_pk_bf16_f32 v53, v133, v149
  v_cvt_pk_bf16_f32 v54, v134, v150
  v_cvt_pk_bf16_f32 v55, v135, v151
  v_cvt_pk_bf16_f32 v56, v136, v152
  v_cvt_pk_bf16_f32 v57, v137, v153
  v_cvt_pk_bf16_f32 v58, v138, v154
  v_cvt_pk_bf16_f32 v59, v139, v155
  v_cvt_pk_bf16_f32 v60, v140, v156
  v_cvt_pk_bf16_f32 v61, v141, v157
  v_cvt_pk_bf16_f32 v62, v142, v158
  v_cvt_pk_bf16_f32 v63, v143, v159
  v_cvt_pk_bf16_f32 v64, v144, v160
  v_cvt_pk_bf16_f32 v65, v145, v161
  v_cvt_pk_bf16_f32 v66, v146, v162
  v_cvt_pk_bf16_f32 v67, v147, v163
  v_permlane32_swap_b32 v52, v54
  v_permlane32_swap_b32 v53, v55
  v_permlane32_swap_b32 v56, v58
  v_permlane32_swap_b32 v57, v59
  v_permlane32_swap_b32 v60, v62
  v_permlane32_swap_b32 v61, v63
  v_permlane32_swap_b32 v64, v66
  v_permlane32_swap_b32 v65, v67
  v_permlane16_swap_b32 v52, v53
  v_permlane16_swap_b32 v54, v55
  v_permlane16_swap_b32 v56, v57
  v_permlane16_swap_b32 v58, v59
  v_permlane16_swap_b32 v60, v61
  v_permlane16_swap_b32 v62, v63
  v_permlane16_swap_b32 v64, v65
  v_permlane16_swap_b32 v66, v67
L_nosp2:
  s_mov_b32 s4, 0
  buffer_store_dwordx4 v[36:39], v15, s[32:35], s4 offen sc1
  s_mov_b32 s4, 16896
  buffer_store_dwordx4 v[40:43], v15, s[32:35], s4 offen sc1
  s_mov_b32 s4, 33792
  buffer_store_dwordx4 v[44:47], v15, s[32:35], s4 offen sc1
  s_mov_b32 s4, 50688
  buffer_store_dwordx4 v[48:51], v15, s[32:35], s4 offen sc1
  s_cmp_eq_u32 s28, 0
  s_cbranch_scc1 L_nosp3
  s_mov_b64 exec, s[6:7]
  s_mov_b32 s4, 4096
  buffer_store_dwordx4 v[52:55], v15, s[32:35], s4 offen sc1
  s_mov_b32 s4, 20992
  buffer_store_dwordx4 v[56:59], v15, s[32:35], s4 offen sc1
  s_mov_b32 s4, 37888
  buffer_store_dwordx4 v[60:63], v15, s[32:35], s4 offen sc1
  s_mov_b32 s4, 54784
  buffer_store_dwordx4 v[64:67], v15, s[32:35], s4 offen sc1
  s_mov_b64 exec, -1
L_nosp3:
  v_mov_b32 v3, 162816
  ds_read_b32 v3, v3
  s_waitcnt lgkmcnt(0)
  v_readfirstlane_b32 s20, v3
  s_nop 1
  s_barrier
  s_barrier
  s_barrier
  s_barrier
  s_add_u32 s3, s26, 11993088
  s_waitcnt vmcnt(0)
  v_mov_b32 v6, s20
  s_mov_b64 exec, 1
  buffer_store_dword v6, off, s[32:35], s3 sc1
  s_mov_b64 exec, -1
  s_branch L_att
L_kv:
  s_and_b32 s3, s19, 1
  s_lshl_b32 s3, s3, 13
  s_add_u32 s3, s3, 65536
  v_add_u32 v12, s3, v4
  v_mov_b32 v64, 0
  v_mov_b32 v65, 0
  v_mov_b32 v66, 0
  v_mov_b32 v67, 0
  v_mov_b32 v68, 0
  v_mov_b32 v69, 0
  v_mov_b32 v70, 0
  v_mov_b32 v71, 0
  v_mov_b32 v72, 0
  v_mov_b32 v73, 0
  v_mov_b32 v74, 0
  v_mov_b32 v75, 0
  v_mov_b32 v76, 0
  v_mov_b32 v77, 0
  v_mov_b32 v78, 0
  v_mov_b32 v79, 0
  v_mov_b32 v80, 0
  v_mov_b32 v81, 0
  v_mov_b32 v82, 0
  v_mov_b32 v83, 0
  v_mov_b32 v84, 0
  v_mov_b32 v85, 0
  v_mov_b32 v86, 0
  v_mov_b32 v87, 0
  v_mov_b32 v88, 0
  v_mov_b32 v89, 0
  v_mov_b32 v90, 0
  v_mov_b32 v91, 0
  v_mov_b32 v92, 0
  v_mov_b32 v93, 0
  v_mov_b32 v94, 0
  v_mov_b32 v95, 0
  s_lshl_b32 s3, s2, 5
  s_add_u32 s3, s3, s19
  s_lshl_b32 s3, s3, 2
  s_add_u32 s31, s3, 11534336
  s_lshl_b32 s3, s17, 2
  s_and_b32 s4, s19, 2
  s_add_u32 s3, s3, s4
  s_lshl_b32 s3, s3, 16
  s_lshl_b32 s4, s16, 11
  s_add_u32 s3, s3, s4
  s_add_u32 s3, s3, 2097152
  v_lshl_add_u32 v14, v0, 4, s3
  s_add_u32 s3, s3, 2097152
  v_bfe_u32 v5, v0, 4, 1
  v_lshlrev_b32 v5, 16, v5
  v_lshl_add_u32 v5, v2, 8, v5
  v_and_b32 v6, 15, v0
  v_lshl_add_u32 v5, v6, 4, v5
  v_add_u32 v16, s3, v5
  v_mov_b32 v21, v4
  s_and_b32 s4, s19, 2
  s_mul_i32 s3, s4, 20480
  s_add_u32 s3, s3, 8192
  v_lshl_add_u32 v17, v0, 4, s3
  s_add_u32 s3, s3, 10240
  v_bfe_u32 v5, v0, 4, 1
  v_mul_u32_u24 v5, 20480, v5
  v_lshl_add_u32 v5, v2, 8, v5
  v_lshl_add_u32 v5, v6, 4, v5
  v_add_u32 v18, s3, v5
  s_and_b32 s3, s19, 1
  s_lshl_b32 s3, s3, 12
  s_lshl_b32 s4, s4, 10
  s_add_u32 s3, s3, s4
  s_add_u32 s3, s3, 81920
  v_lshl_add_u32 v20, v0, 4, s3
  s_mov_b32 s8, 0x3eb8aa3b
  s_mov_b32 s9, s8
  s_mov_b32 s25, 0
  s_mov_b32 s30, 0
  s_mov_b32 s27, 24576
  s_waitcnt lgkmcnt(0)
  s_barrier
  ds_read_b128 v[96:99], v8 offset:0
  ds_read_b128 v[100:103], v8 offset:4096
  ds_read_b64_tr_b16 v[104:105], v12 offset:0
  ds_read_b64_tr_b16 v[106:107], v12 offset:512
  ds_read_b128 v[108:111], v9 offset:0
  ds_read_b128 v[112:115], v9 offset:4096
  ds_read_b64_tr_b16 v[116:117], v12 offset:2048
  ds_read_b64_tr_b16 v[118:119], v12 offset:2560
  s_bitcmp1_b32 s19, 0
  s_cbranch_scc1 L_loopV
.p2align 6
L_loopK:
  s_waitcnt lgkmcnt(4)
  v_mfma_f32_32x32x16_bf16 v[64:79], v[104:107], v[96:99], v[64:79]
  ds_read_b128 v[120:123], v10 offset:0
  ds_read_b128 v[124:127], v10 offset:4096
  v_mfma_f32_32x32x16_bf16 v[80:95], v[104:107], v[100:103], v[80:95]
  ds_read_b64_tr_b16 v[128:129], v12 offset:4096
  ds_read_b64_tr_b16 v[130:131], v12 offset:4608
  s_waitcnt lgkmcnt(4)
  v_mfma_f32_32x32x16_bf16 v[64:79], v[116:119], v[108:111], v[64:79]
  ds_read_b128 v[132:135], v11 offset:0
  ds_read_b128 v[136:139], v11 offset:4096
  v_mfma_f32_32x32x16_bf16 v[80:95], v[116:119], v[112:115], v[80:95]
  ds_read_b64_tr_b16 v[140:141], v12 offset:6144
  ds_read_b64_tr_b16 v[142:143], v12 offset:6656
  s_waitcnt lgkmcnt(4)
  v_mfma_f32_32x32x16_bf16 v[64:79], v[128:131], v[120:123], v[64:79]
  v_mfma_f32_32x32x16_bf16 v[80:95], v[128:131], v[124:127], v[80:95]
  s_add_u32 s30, s30, 1
  s_cmp_eq_u32 s30, 3
  s_cselect_b32 s26, -49152, s27
  s_cselect_b32 s30, 0, s30
  v_add_u32 v12, s26, v12
  v_add_u32 v8, 8192, v8
  v_add_u32 v9, 8192, v9
  v_add_u32 v10, 8192, v10
  v_add_u32 v11, 8192, v11
  s_add_u32 s25, s25, 1
  s_cmp_eq_u32 s25, 8
  s_waitcnt lgkmcnt(0)
  s_cbranch_scc1 L_lastK
  s_barrier
  ds_read_b128 v[96:99], v8 offset:0
  ds_read_b128 v[100:103], v8 offset:4096
  ds_read_b64_tr_b16 v[104:105], v12 offset:0
  ds_read_b64_tr_b16 v[106:107], v12 offset:512
  v_mfma_f32_32x32x16_bf16 v[64:79], v[140:143], v[132:135], v[64:79]
  ds_read_b128 v[108:111], v9 offset:0
  ds_read_b128 v[112:115], v9 offset:4096
  v_mfma_f32_32x32x16_bf16 v[80:95], v[140:143], v[136:139], v[80:95]
  ds_read_b64_tr_b16 v[116:117], v12 offset:2048
  ds_read_b64_tr_b16 v[118:119], v12 offset:2560
  s_branch L_loopK
L_lastK:
  v_mfma_f32_32x32x16_bf16 v[64:79], v[140:143], v[132:135], v[64:79]
  v_mfma_f32_32x32x16_bf16 v[80:95], v[140:143], v[136:139], v[80:95]
  s_mov_b32 s4, 65536
  s_nop 9
  v_cvt_pk_bf16_f32 v32, v64, v65
  v_cvt_pk_bf16_f32 v33, v66, v67
  v_cvt_pk_bf16_f32 v34, v68, v69
  v_cvt_pk_bf16_f32 v35, v70, v71
  buffer_store_dwordx4 v[32:35], v14, s[32:35], 0 offen offset:0 sc1
  v_cvt_pk_bf16_f32 v36, v72, v73
  v_cvt_pk_bf16_f32 v37, v74, v75
  v_cvt_pk_bf16_f32 v38, v76, v77
  v_cvt_pk_bf16_f32 v39, v78, v79
  buffer_store_dwordx4 v[36:39], v14, s[32:35], s4 offen offset:0 sc1
  v_cvt_pk_bf16_f32 v40, v80, v81
  v_cvt_pk_bf16_f32 v41, v82, v83
  v_cvt_pk_bf16_f32 v42, v84, v85
  v_cvt_pk_bf16_f32 v43, v86, v87
  buffer_store_dwordx4 v[40:43], v14, s[32:35], 0 offen offset:1024 sc1
  v_cvt_pk_bf16_f32 v44, v88, v89
  v_cvt_pk_bf16_f32 v45, v90, v91
  v_cvt_pk_bf16_f32 v46, v92, v93
  v_cvt_pk_bf16_f32 v47, v94, v95
  buffer_store_dwordx4 v[44:47], v14, s[32:35], s4 offen offset:1024 sc1
  s_branch L_kvdone
.p2align 6
L_loopV:
  s_waitcnt lgkmcnt(4)
  v_mfma_f32_32x32x16_bf16 v[64:79], v[96:99], v[104:107], v[64:79]
  ds_read_b128 v[120:123], v10 offset:0
  ds_read_b128 v[124:127], v10 offset:4096
  v_mfma_f32_32x32x16_bf16 v[80:95], v[100:103], v[104:107], v[80:95]
  ds_read_b64_tr_b16 v[128:129], v12 offset:4096
  ds_read_b64_tr_b16 v[130:131], v12 offset:4608
  s_waitcnt lgkmcnt(4)
  v_mfma_f32_32x32x16_bf16 v[64:79], v[108:111], v[116:119], v[64:79]
  ds_read_b128 v[132:135], v11 offset:0
  ds_read_b128 v[136:139], v11 offset:4096
  v_mfma_f32_32x32x16_bf16 v[80:95], v[112:115], v[116:119], v[80:95]
  ds_read_b64_tr_b16 v[140:141], v12 offset:6144
  ds_read_b64_tr_b16 v[142:143], v12 offset:6656
  s_waitcnt lgkmcnt(4)
  v_mfma_f32_32x32x16_bf16 v[64:79], v[120:123], v[128:131], v[64:79]
  v_mfma_f32_32x32x16_bf16 v[80:95], v[124:127], v[128:131], v[80:95]
  s_add_u32 s30, s30, 1
  s_cmp_eq_u32 s30, 3
  s_cselect_b32 s26, -49152, s27
  s_cselect_b32 s30, 0, s30
  v_add_u32 v12, s26, v12
  v_add_u32 v8, 8192, v8
  v_add_u32 v9, 8192, v9
  v_add_u32 v10, 8192, v10
  v_add_u32 v11, 8192, v11
  s_add_u32 s25, s25, 1
  s_cmp_eq_u32 s25, 8
  s_waitcnt lgkmcnt(0)
  s_cbranch_scc1 L_lastV
  s_barrier
  ds_read_b128 v[96:99], v8 offset:0
  ds_read_b128 v[100:103], v8 offset:4096
  ds_read_b64_tr_b16 v[104:105], v12 offset:0
  ds_read_b64_tr_b16 v[106:107], v12 offset:512
  v_mfma_f32_32x32x16_bf16 v[64:79], v[132:135], v[140:143], v[64:79]
  ds_read_b128 v[108:111], v9 offset:0
  ds_read_b128 v[112:115], v9 offset:4096
  v_mfma_f32_32x32x16_bf16 v[80:95], v[136:139], v[140:143], v[80:95]
  ds_read_b64_tr_b16 v[116:117], v12 offset:2048
  ds_read_b64_tr_b16 v[118:119], v12 offset:2560
  s_branch L_loopV
L_lastV:
  v_mfma_f32_32x32x16_bf16 v[64:79], v[132:135], v[140:143], v[64:79]
  v_mfma_f32_32x32x16_bf16 v[80:95], v[136:139], v[140:143], v[80:95]
  s_mov_b32 s4, 65536
  s_nop 9
  v_cvt_pk_bf16_f32 v32, v64, v65
  v_cvt_pk_bf16_f32 v33, v66, v67
  v_cvt_pk_bf16_f32 v34, v68, v69
  v_cvt_pk_bf16_f32 v35, v70, v71
  buffer_store_dwordx4 v[32:35], v16, s[32:35], 0 offen offset:0 sc1
  v_cvt_pk_bf16_f32 v36, v72, v73
  v_cvt_pk_bf16_f32 v37, v74, v75
  v_cvt_pk_bf16_f32 v38, v76, v77
  v_cvt_pk_bf16_f32 v39, v78, v79
  buffer_store_dwordx4 v[36:39], v16, s[32:35], 0 offen offset:512 sc1
  v_cvt_pk_bf16_f32 v40, v80, v81
  v_cvt_pk_bf16_f32 v41, v82, v83
  v_cvt_pk_bf16_f32 v42, v84, v85
  v_cvt_pk_bf16_f32 v43, v86, v87
  buffer_store_dwordx4 v[40:43], v16, s[32:35], 0 offen offset:1024 sc1
  v_cvt_pk_bf16_f32 v44, v88, v89
  v_cvt_pk_bf16_f32 v45, v90, v91
  v_cvt_pk_bf16_f32 v46, v92, v93
  v_cvt_pk_bf16_f32 v47, v94, v95
  buffer_store_dwordx4 v[44:47], v16, s[32:35], 0 offen offset:1536 sc1
L_kvdone:
  s_and_b32 s3, s19, 1
  s_lshl_b32 s3, s3, 12
  s_sub_u32 s3, s3, 65536
  v_add_u32 v12, 114688, v21
  v_add_u32 v8, s3, v8
  v_add_u32 v9, s3, v9
  v_add_u32 v10, s3, v10
  v_add_u32 v11, s3, v11
  v_mov_b32 v19, 162816
  s_barrier
  ds_read_b32 v19, v19
  ds_read_b128 v[96:99], v8 offset:0
  ds_read_b64_tr_b16 v[100:101], v12 offset:0
  ds_read_b64_tr_b16 v[102:103], v12 offset:512
  ds_read_b128 v[104:107], v9 offset:0
  ds_read_b64_tr_b16 v[108:109], v12 offset:2048
  ds_read_b64_tr_b16 v[110:111], v12 offset:2560
  ds_read_b128 v[112:115], v10 offset:0
  ds_read_b64_tr_b16 v[116:117], v12 offset:4096
  ds_read_b64_tr_b16 v[118:119], v12 offset:4608
  s_waitcnt lgkmcnt(6)
  v_mfma_f32_32x32x16_bf16 v[64:79], v[100:103], v[96:99], 0
  ds_read_b128 v[120:123], v11 offset:0
  ds_read_b64_tr_b16 v[124:125], v12 offset:6144
  ds_read_b64_tr_b16 v[126:127], v12 offset:6656
  s_waitcnt lgkmcnt(6)
  v_mfma_f32_32x32x16_bf16 v[64:79], v[108:111], v[104:107], v[64:79]
  ds_read_b128 v[96:99], v8 offset:8192
  ds_read_b64_tr_b16 v[100:101], v12 offset:8192
  ds_read_b64_tr_b16 v[102:103], v12 offset:8704
  s_waitcnt lgkmcnt(6)
  v_mfma_f32_32x32x16_bf16 v[64:79], v[116:119], v[112:115], v[64:79]
  ds_read_b128 v[104:107], v9 offset:8192
  ds_read_b64_tr_b16 v[108:109], v12 offset:10240
  ds_read_b64_tr_b16 v[110:111], v12 offset:10752
  s_waitcnt lgkmcnt(6)
  v_mfma_f32_32x32x16_bf16 v[64:79], v[124:127], v[120:123], v[64:79]
  ds_read_b128 v[112:115], v10 offset:8192
  ds_read_b64_tr_b16 v[116:117], v12 offset:12288
  ds_read_b64_tr_b16 v[118:119], v12 offset:12800
  s_waitcnt lgkmcnt(6)
  v_mfma_f32_32x32x16_bf16 v[64:79], v[100:103], v[96:99], v[64:79]
  ds_read_b128 v[120:123], v11 offset:8192
  ds_read_b64_tr_b16 v[124:125], v12 offset:14336
  ds_read_b64_tr_b16 v[126:127], v12 offset:14848
  v_readfirstlane_b32 s20, v19
  s_nop 1
  s_waitcnt vmcnt(0)
  v_mov_b32 v6, s20
  s_mov_b64 exec, 1
  buffer_store_dword v6, off, s[32:35], s31 sc1
  s_mov_b64 exec, -1
  s_waitcnt lgkmcnt(0)
  s_barrier
  v_add_u32 v12, -49152, v12
  v_mfma_f32_32x32x16_bf16 v[64:79], v[108:111], v[104:107], v[64:79]
  ds_read_b128 v[96:99], v8 offset:16384
  ds_read_b64_tr_b16 v[100:101], v12 offset:0
  ds_read_b64_tr_b16 v[102:103], v12 offset:512
  v_mfma_f32_32x32x16_bf16 v[64:79], v[116:119], v[112:115], v[64:79]
  ds_read_b128 v[104:107], v9 offset:16384
  ds_read_b64_tr_b16 v[108:109], v12 offset:2048
  ds_read_b64_tr_b16 v[110:111], v12 offset:2560
  v_mfma_f32_32x32x16_bf16 v[64:79], v[124:127], v[120:123], v[64:79]
  ds_read_b128 v[112:115], v10 offset:16384
  ds_read_b64_tr_b16 v[116:117], v12 offset:4096
  ds_read_b64_tr_b16 v[118:119], v12 offset:4608
  s_waitcnt lgkmcnt(6)
  v_mfma_f32_32x32x16_bf16 v[64:79], v[100:103], v[96:99], v[64:79]
  ds_read_b128 v[120:123], v11 offset:16384
  ds_read_b64_tr_b16 v[124:125], v12 offset:6144
  ds_read_b64_tr_b16 v[126:127], v12 offset:6656
  s_waitcnt lgkmcnt(6)
  v_mfma_f32_32x32x16_bf16 v[64:79], v[108:111], v[104:107], v[64:79]
  ds_read_b128 v[96:99], v8 offset:24576
  ds_read_b64_tr_b16 v[100:101], v12 offset:8192
  ds_read_b64_tr_b16 v[102:103], v12 offset:8704
  s_waitcnt lgkmcnt(6)
  v_mfma_f32_32x32x16_bf16 v[64:79], v[116:119], v[112:115], v[64:79]
  ds_read_b128 v[104:107], v9 offset:24576
  ds_read_b64_tr_b16 v[108:109], v12 offset:10240
  ds_read_b64_tr_b16 v[110:111], v12 offset:10752
  s_waitcnt lgkmcnt(6)
  v_mfma_f32_32x32x16_bf16 v[64:79], v[124:127], v[120:123], v[64:79]
  ds_read_b128 v[112:115], v10 offset:24576
  ds_read_b64_tr_b16 v[116:117], v12 offset:12288
  ds_read_b64_tr_b16 v[118:119], v12 offset:12800
  s_waitcnt lgkmcnt(6)
  v_mfma_f32_32x32x16_bf16 v[64:79], v[100:103], v[96:99], v[64:79]
  ds_read_b128 v[120:123], v11 offset:24576
  ds_read_b64_tr_b16 v[124:125], v12 offset:14336
  ds_read_b64_tr_b16 v[126:127], v12 offset:14848
  s_waitcnt lgkmcnt(0)
  s_barrier
  v_add_u32 v12, 73728, v12
  v_mfma_f32_32x32x16_bf16 v[64:79], v[108:111], v[104:107], v[64:79]
  ds_read_b128 v[96:99], v8 offset:32768
  ds_read_b64_tr_b16 v[100:101], v12 offset:0
  ds_read_b64_tr_b16 v[102:103], v12 offset:512
  v_mfma_f32_32x32x16_bf16 v[64:79], v[116:119], v[112:115], v[64:79]
  ds_read_b128 v[104:107], v9 offset:32768
  ds_read_b64_tr_b16 v[108:109], v12 offset:2048
  ds_read_b64_tr_b16 v[110:111], v12 offset:2560
  v_mfma_f32_32x32x16_bf16 v[64:79], v[124:127], v[120:123], v[64:79]
  ds_read_b128 v[112:115], v10 offset:32768
  ds_read_b64_tr_b16 v[116:117], v12 offset:4096
  ds_read_b64_tr_b16 v[118:119], v12 offset:4608
  s_waitcnt lgkmcnt(6)
  v_mfma_f32_32x32x16_bf16 v[64:79], v[100:103], v[96:99], v[64:79]
  ds_read_b128 v[120:123], v11 offset:32768
  ds_read_b64_tr_b16 v[124:125], v12 offset:6144
  ds_read_b64_tr_b16 v[126:127], v12 offset:6656
  s_waitcnt lgkmcnt(6)
  v_mfma_f32_32x32x16_bf16 v[64:79], v[108:111], v[104:107], v[64:79]
  ds_read_b128 v[96:99], v8 offset:40960
  ds_read_b64_tr_b16 v[100:101], v12 offset:8192
  ds_read_b64_tr_b16 v[102:103], v12 offset:8704
  s_waitcnt lgkmcnt(6)
  v_mfma_f32_32x32x16_bf16 v[64:79], v[116:119], v[112:115], v[64:79]
  ds_read_b128 v[104:107], v9 offset:40960
  ds_read_b64_tr_b16 v[108:109], v12 offset:10240
  ds_read_b64_tr_b16 v[110:111], v12 offset:10752
  s_waitcnt lgkmcnt(6)
  v_mfma_f32_32x32x16_bf16 v[64:79], v[124:127], v[120:123], v[64:79]
  ds_read_b128 v[112:115], v10 offset:40960
  ds_read_b64_tr_b16 v[116:117], v12 offset:12288
  ds_read_b64_tr_b16 v[118:119], v12 offset:12800
  s_waitcnt lgkmcnt(6)
  v_mfma_f32_32x32x16_bf16 v[64:79], v[100:103], v[96:99], v[64:79]
  ds_read_b128 v[120:123], v11 offset:40960
  ds_read_b64_tr_b16 v[124:125], v12 offset:14336
  ds_read_b64_tr_b16 v[126:127], v12 offset:14848
  s_waitcnt lgkmcnt(0)
  s_barrier
  v_add_u32 v12, -49152, v12
  v_mfma_f32_32x32x16_bf16 v[64:79], v[108:111], v[104:107], v[64:79]
  ds_read_b128 v[96:99], v8 offset:49152
  ds_read_b64_tr_b16 v[100:101], v12 offset:0
  ds_read_b64_tr_b16 v[102:103], v12 offset:512
  v_mfma_f32_32x32x16_bf16 v[64:79], v[116:119], v[112:115], v[64:79]
  ds_read_b128 v[104:107], v9 offset:49152
  ds_read_b64_tr_b16 v[108:109], v12 offset:2048
  ds_read_b64_tr_b16 v[110:111], v12 offset:2560
  v_mfma_f32_32x32x16_bf16 v[64:79], v[124:127], v[120:123], v[64:79]
  ds_read_b128 v[112:115], v10 offset:49152
  ds_read_b64_tr_b16 v[116:117], v12 offset:4096
  ds_read_b64_tr_b16 v[118:119], v12 offset:4608
  s_waitcnt lgkmcnt(6)
  v_mfma_f32_32x32x16_bf16 v[64:79], v[100:103], v[96:99], v[64:79]
  ds_read_b128 v[120:123], v11 offset:49152
  ds_read_b64_tr_b16 v[124:125], v12 offset:6144
  ds_read_b64_tr_b16 v[126:127], v12 offset:6656
  s_waitcnt lgkmcnt(6)
  v_mfma_f32_32x32x16_bf16 v[64:79], v[108:111], v[104:107], v[64:79]
  ds_read_b128 v[96:99], v8 offset:57344
  ds_read_b64_tr_b16 v[100:101], v12 offset:8192
  ds_read_b64_tr_b16 v[102:103], v12 offset:8704
  s_waitcnt lgkmcnt(6)
  v_mfma_f32_32x32x16_bf16 v[64:79], v[116:119], v[112:115], v[64:79]
  ds_read_b128 v[104:107], v9 offset:57344
  ds_read_b64_tr_b16 v[108:109], v12 offset:10240
  ds_read_b64_tr_b16 v[110:111], v12 offset:10752
  s_waitcnt lgkmcnt(6)
  v_mfma_f32_32x32x16_bf16 v[64:79], v[124:127], v[120:123], v[64:79]
  ds_read_b128 v[112:115], v10 offset:57344
  ds_read_b64_tr_b16 v[116:117], v12 offset:12288
  ds_read_b64_tr_b16 v[118:119], v12 offset:12800
  s_waitcnt lgkmcnt(6)
  v_mfma_f32_32x32x16_bf16 v[64:79], v[100:103], v[96:99], v[64:79]
  ds_read_b128 v[120:123], v11 offset:57344
  ds_read_b64_tr_b16 v[124:125], v12 offset:14336
  ds_read_b64_tr_b16 v[126:127], v12 offset:14848
  s_waitcnt lgkmcnt(6)
  v_mfma_f32_32x32x16_bf16 v[64:79], v[108:111], v[104:107], v[64:79]
  s_waitcnt lgkmcnt(3)
  v_mfma_f32_32x32x16_bf16 v[64:79], v[116:119], v[112:115], v[64:79]
  s_waitcnt lgkmcnt(0)
  v_mfma_f32_32x32x16_bf16 v[64:79], v[124:127], v[120:123], v[64:79]
  s_barrier
  s_bitcmp1_b32 s19, 0
  s_cbranch_scc1 L_cpv
  ds_write_b128 v17, v[32:35] offset:0
  ds_write_b128 v17, v[36:39] offset:20480
  ds_write_b128 v17, v[40:43] offset:1024
  ds_write_b128 v17, v[44:47] offset:21504
  s_branch L_cpq
L_cpv:
  ds_write_b128 v18, v[32:35] offset:0
  ds_write_b128 v18, v[36:39] offset:512
  ds_write_b128 v18, v[40:43] offset:1024
  ds_write_b128 v18, v[44:47] offset:1536
L_cpq:
  s_nop 5
  v_pk_mul_f32 v[64:65], v[64:65], s[8:9]
  v_pk_mul_f32 v[66:67], v[66:67], s[8:9]
  v_pk_mul_f32 v[68:69], v[68:69], s[8:9]
  v_pk_mul_f32 v[70:71], v[70:71], s[8:9]
  v_pk_mul_f32 v[72:73], v[72:73], s[8:9]
  v_pk_mul_f32 v[74:75], v[74:75], s[8:9]
  v_pk_mul_f32 v[76:77], v[76:77], s[8:9]
  v_pk_mul_f32 v[78:79], v[78:79], s[8:9]
  v_cvt_pk_bf16_f32 v96, v64, v65
  v_cvt_pk_bf16_f32 v97, v66, v67
  v_cvt_pk_bf16_f32 v98, v68, v69
  v_cvt_pk_bf16_f32 v99, v70, v71
  v_cvt_pk_bf16_f32 v100, v72, v73
  v_cvt_pk_bf16_f32 v101, v74, v75
  v_cvt_pk_bf16_f32 v102, v76, v77
  v_cvt_pk_bf16_f32 v103, v78, v79
  ds_write_b128 v20, v[96:99]
  ds_write_b128 v20, v[100:103] offset:1024
  s_lshl_b32 s3, s19, 2
  s_add_u32 s3, s3, 110592
  v_mov_b32 v5, s3
  v_mov_b32 v6, 1
  s_waitcnt lgkmcnt(0)
  ds_write_b32 v5, v6
L_att:
  v_mov_b32 v5, 162816
  ds_read_b32 v5, v5
  s_waitcnt lgkmcnt(0)
  v_readfirstlane_b32 s20, v5
  s_nop 1
  s_xor_b32 s14, s14, s20
  s_and_b32 s3, s19, 3
  s_lshr_b32 s5, s19, 2
  s_lshl_b32 s4, s17, 2
  s_add_u32 s21, s4, s3
  s_lshl_b32 s4, s16, 1
  s_add_u32 s4, s4, s5
  s_lshl_b32 s12, s4, 10
  s_lshl_b32 s6, s21, 16
  s_add_u32 s12, s12, s6
  s_min_u32 s10, s4, 7
  s_lshl_b32 s4, s4, 5
  s_add_u32 s4, s4, s21
  s_lshl_b32 s4, s4, 2
  s_add_u32 s13, s4, 11665408
  v_lshlrev_b32 v1, 4, v0
  s_lshl_b32 s4, s19, 10
  s_add_u32 s4, s4, 81920
  v_add_u32 v4, s4, v1
  s_lshl_b32 s4, s3, 2
  s_add_u32 s4, s4, 90112
  v_mov_b32 v149, s4
  s_mul_i32 s4, s3, 20480
  s_lshl_b32 s5, s5, 10
  s_add_u32 s4, s4, s5
  v_add_u32 v2, s4, v1
  v_lshrrev_b32 v10, 5, v0
  v_and_b32 v11, 15, v0
  v_lshlrev_b32 v11, 4, v11
  v_lshl_add_u32 v11, v10, 8, v11
  s_add_u32 s4, s4, 10240
  v_add_u32 v3, s4, v11
  v_mov_b32 v8, 0xff800000
  s_mov_b32 s8, 0x0000ffff
  s_mov_b32 s9, 0x0000ffff
  s_mov_b32 s6, 0x00110000
  s_mov_b32 s7, 0x00110000
  v_mov_b32 v10, 0x3f803f80
  v_cndmask_b32 v24, 0, v10, s[6:7]
  v_cndmask_b32 v25, 0, v10, s[6:7]
  v_cndmask_b32 v26, 0, v10, s[6:7]
  v_cndmask_b32 v27, 0, v10, s[6:7]
  v_cndmask_b32 v28, 0, v10, s[6:7]
  v_cndmask_b32 v29, 0, v10, s[6:7]
  v_cndmask_b32 v30, 0, v10, s[6:7]
  v_cndmask_b32 v31, 0, v10, s[6:7]
  v_cndmask_b32 v32, 0, v10, s[6:7]
  v_cndmask_b32 v33, 0, v10, s[6:7]
  v_cndmask_b32 v34, 0, v10, s[6:7]
  v_cndmask_b32 v35, 0, v10, s[6:7]
  v_cndmask_b32 v36, 0, v10, s[6:7]
  v_cndmask_b32 v37, 0, v10, s[6:7]
  v_cndmask_b32 v38, 0, v10, s[6:7]
  v_cndmask_b32 v39, 0, v10, s[6:7]
  v_mov_b32 v10, 0xffff
  v_mov_b32 v11, 0xffff0000
  v_cndmask_b32 v136, 0, v10, s[64:65]
  v_cndmask_b32 v5, 0, v11, s[66:67]
  v_or_b32 v136, v136, v5
  v_cndmask_b32 v137, 0, v10, s[68:69]
  v_cndmask_b32 v5, 0, v11, s[70:71]
  v_or_b32 v137, v137, v5
  v_cndmask_b32 v138, 0, v10, s[72:73]
  v_cndmask_b32 v5, 0, v11, s[74:75]
  v_or_b32 v138, v138, v5
  v_cndmask_b32 v139, 0, v10, s[76:77]
  v_cndmask_b32 v5, 0, v11, s[78:79]
  v_or_b32 v139, v139, v5
  v_cndmask_b32 v140, 0, v10, s[80:81]
  v_cndmask_b32 v5, 0, v11, s[82:83]
  v_or_b32 v140, v140, v5
  v_cndmask_b32 v141, 0, v10, s[84:85]
  v_cndmask_b32 v5, 0, v11, s[86:87]
  v_or_b32 v141, v141, v5
  v_cndmask_b32 v142, 0, v10, s[88:89]
  v_cndmask_b32 v5, 0, v11, s[90:91]
  v_or_b32 v142, v142, v5
  v_cndmask_b32 v143, 0, v10, s[92:93]
  v_cndmask_b32 v5, 0, v11, s[94:95]
  v_or_b32 v143, v143, v5
  v_mov_b32 v5, 110592
  s_mov_b32 s60, 0
L_ownw:
  ds_read_b128 v[12:15], v5
  s_add_u32 s60, s60, 1
  s_cmp_gt_u32 s60, 1600000
  s_cbranch_scc1 L_ownx
  s_waitcnt lgkmcnt(0)
  v_and_b32 v12, v12, v13
  v_and_b32 v14, v14, v15
  v_and_b32 v12, v12, v14
  v_cmp_eq_u32 vcc, 0, v12
  s_cbranch_vccnz L_ownw
L_ownx:
  ds_read_b128 v[4:7], v4
  s_setprio 3
  s_cmp_eq_u32 s22, 0
  s_cbranch_scc1 L_first
  s_cmp_lt_u32 s19, 4
  s_cbranch_scc1 L_q00
  ds_read_b128 v[12:15], v2 offset:7168
  s_mov_b64 exec, s[8:9]
  ds_read_b128 v[24:27], v3 offset:7168
  ds_read_b128 v[28:31], v3 offset:7680
  s_mov_b64 exec, -1
  s_waitcnt lgkmcnt(2)
  v_mfma_f32_32x32x16_bf16 v[64:79], v[12:15], v[4:7], 0
  s_nop 11
  v_max3_f32 v9, v64, v65, v66
  v_max3_f32 v10, v67, v68, v69
  v_max3_f32 v11, v70, v71, v72
  v_max3_f32 v9, v73, v74, v9
  v_max3_f32 v10, v75, v76, v10
  v_max3_f32 v11, v77, v78, v11
  v_max3_f32 v9, v79, v9, v10
  v_max_f32 v9, v9, v11
  v_mov_b32 v10, v9
  s_nop 1
  v_permlane32_swap_b32 v10, v9
  s_nop 1
  v_max_f32 v9, v9, v10
  v_sub_f32 v96, 0xc2700000, v9
  v_mov_b32 v97, v96
  v_mov_b32 v98, v96
  v_mov_b32 v99, v96
  v_mov_b32 v100, v96
  v_mov_b32 v101, v96
  v_mov_b32 v102, v96
  v_mov_b32 v103, v96
  v_mov_b32 v104, v96
  v_mov_b32 v105, v96
  v_mov_b32 v106, v96
  v_mov_b32 v107, v96
  v_mov_b32 v108, v96
  v_mov_b32 v109, v96
  v_mov_b32 v110, v96
  v_mov_b32 v111, v96
  s_nop 1
  v_mfma_f32_32x32x16_bf16 v[48:63], v[12:15], v[4:7], v[96:111]
  s_nop 11
  v_exp_f32 v48, v48
  v_exp_f32 v49, v49
  v_exp_f32 v50, v50
  v_exp_f32 v51, v51
  v_exp_f32 v52, v52
  v_exp_f32 v53, v53
  v_exp_f32 v54, v54
  v_exp_f32 v55, v55
  v_exp_f32 v56, v56
  v_exp_f32 v57, v57
  v_exp_f32 v58, v58
  v_exp_f32 v59, v59
  v_cvt_pk_bf16_f32 v40, v48, v49
  v_cvt_pk_bf16_f32 v41, v50, v51
  v_cvt_pk_bf16_f32 v42, v52, v53
  v_cvt_pk_bf16_f32 v43, v54, v55
  v_exp_f32 v60, v60
  s_waitcnt lgkmcnt(0)
  v_mfma_f32_32x32x16_bf16 v[80:95], v[24:27], v[40:43], 0
  v_exp_f32 v61, v61
  v_exp_f32 v62, v62
  v_exp_f32 v63, v63
  v_cvt_pk_bf16_f32 v44, v56, v57
  v_cvt_pk_bf16_f32 v45, v58, v59
  v_cvt_pk_bf16_f32 v46, v60, v61
  v_cvt_pk_bf16_f32 v47, v62, v63
  s_barrier
  ds_read_b128 v[16:19], v2 offset:6144
  s_barrier
  ds_read_b128 v[20:23], v2 offset:5120
  s_mov_b64 exec, s[8:9]
  ds_read_b128 v[32:35], v3 offset:6144
  ds_read_b128 v[36:39], v3 offset:6656
  s_mov_b64 exec, -1
  s_waitcnt lgkmcnt(3)
  v_mfma_f32_32x32x16_bf16 v[64:79], v[16:19], v[4:7], v[96:111]
  s_nop 10
  s_branch L_n10
L_q00:
  ds_read_b128 v[20:23], v2 offset:8192
  s_waitcnt lgkmcnt(0)
  v_mfma_f32_32x32x16_bf16 v[64:79], v[20:23], v[4:7], 0
  s_nop 11
  v_cndmask_b32 v64, v8, v64, s[64:65]
  v_cndmask_b32 v65, v8, v65, s[66:67]
  v_cndmask_b32 v66, v8, v66, s[68:69]
  v_cndmask_b32 v67, v8, v67, s[70:71]
  v_cndmask_b32 v68, v8, v68, s[72:73]
  v_cndmask_b32 v69, v8, v69, s[74:75]
  v_cndmask_b32 v70, v8, v70, s[76:77]
  v_cndmask_b32 v71, v8, v71, s[78:79]
  v_cndmask_b32 v72, v8, v72, s[80:81]
  v_cndmask_b32 v73, v8, v73, s[82:83]
  v_cndmask_b32 v74, v8, v74, s[84:85]
  v_cndmask_b32 v75, v8, v75, s[86:87]
  v_cndmask_b32 v76, v8, v76, s[88:89]
  v_cndmask_b32 v77, v8, v77, s[90:91]
  v_cndmask_b32 v78, v8, v78, s[92:93]
  v_cndmask_b32 v79, v8, v79, s[94:95]
  v_max3_f32 v9, v64, v65, v66
  v_max3_f32 v10, v67, v68, v69
  v_max3_f32 v11, v70, v71, v72
  v_max3_f32 v9, v73, v74, v9
  v_max3_f32 v10, v75, v76, v10
  v_max3_f32 v11, v77, v78, v11
  v_max3_f32 v9, v79, v9, v10
  v_max_f32 v9, v9, v11
  v_mov_b32 v10, v9
  s_nop 1
  v_permlane32_swap_b32 v10, v9
  s_nop 1
  v_max_f32 v9, v9, v10
  v_sub_f32 v96, 0xc2700000, v9
  v_mov_b32 v97, v96
  v_mov_b32 v98, v96
  v_mov_b32 v99, v96
  v_mov_b32 v100, v96
  v_mov_b32 v101, v96
  v_mov_b32 v102, v96
  v_mov_b32 v103, v96
  v_mov_b32 v104, v96
  v_mov_b32 v105, v96
  v_mov_b32 v106, v96
  v_mov_b32 v107, v96
  v_mov_b32 v108, v96
  v_mov_b32 v109, v96
  v_mov_b32 v110, v96
  v_mov_b32 v111, v96
  s_barrier
  ds_read_b128 v[12:15], v2 offset:7168
  ds_read_b128 v[16:19], v2 offset:6144
  s_mov_b64 exec, s[8:9]
  ds_read_b128 v[24:27], v3 offset:7168
  ds_read_b128 v[28:31], v3 offset:7680
  s_mov_b64 exec, -1
  s_waitcnt lgkmcnt(3)
  v_mfma_f32_32x32x16_bf16 v[48:63], v[12:15], v[4:7], v[96:111]
  s_waitcnt lgkmcnt(2)
  v_mfma_f32_32x32x16_bf16 v[64:79], v[16:19], v[4:7], v[96:111]
  s_barrier
  ds_read_b128 v[20:23], v2 offset:5120
  s_mov_b64 exec, s[8:9]
  ds_read_b128 v[32:35], v3 offset:6144
  ds_read_b128 v[36:39], v3 offset:6656
  s_mov_b64 exec, -1
  s_nop 3
  v_exp_f32 v48, v48
  v_exp_f32 v49, v49
  v_exp_f32 v50, v50
  v_exp_f32 v51, v51
  v_exp_f32 v52, v52
  v_exp_f32 v53, v53
  v_exp_f32 v54, v54
  v_exp_f32 v55, v55
  v_cvt_pk_bf16_f32 v40, v48, v49
  v_cvt_pk_bf16_f32 v41, v50, v51
  v_cvt_pk_bf16_f32 v42, v52, v53
  v_cvt_pk_bf16_f32 v43, v54, v55
  v_exp_f32 v56, v56
  v_exp_f32 v57, v57
  v_exp_f32 v58, v58
  v_exp_f32 v59, v59
  s_waitcnt lgkmcnt(3)
  v_mfma_f32_32x32x16_bf16 v[80:95], v[24:27], v[40:43], 0
  v_exp_f32 v60, v60
  v_exp_f32 v61, v61
  v_exp_f32 v62, v62
  v_exp_f32 v63, v63
  v_cvt_pk_bf16_f32 v44, v56, v57
  v_cvt_pk_bf16_f32 v45, v58, v59
  v_cvt_pk_bf16_f32 v46, v60, v61
  v_cvt_pk_bf16_f32 v47, v62, v63
L_n10:
  v_and_b32 v147, 31, v0
  s_lshl_b32 s3, s22, 7
  s_add_u32 s3, s3, 11927552
  v_lshl_add_u32 v147, v147, 2, s3
  buffer_load_dword v148, v147, s[32:35], 0 offen sc1
  v_exp_f32 v64, v64
  v_exp_f32 v65, v65
  v_exp_f32 v66, v66
  v_exp_f32 v67, v67
  v_mfma_f32_32x32x16_bf16 v[80:95], v[28:31], v[44:47], v[80:95]
  v_exp_f32 v68, v68
  v_exp_f32 v69, v69
  v_exp_f32 v70, v70
  v_exp_f32 v71, v71
  s_waitcnt lgkmcnt(2)
  v_mfma_f32_32x32x16_bf16 v[48:63], v[20:23], v[4:7], v[96:111]
  ds_read_b32 v11, v149
  ds_read_b128 v[12:15], v2 offset:4096
  s_mov_b64 exec, s[8:9]
  ds_read_b128 v[24:27], v3 offset:5120
  ds_read_b128 v[28:31], v3 offset:5632
  s_mov_b64 exec, -1
  v_cvt_pk_bf16_f32 v128, v64, v65
  v_cvt_pk_bf16_f32 v129, v66, v67
  v_cvt_pk_bf16_f32 v130, v68, v69
  v_cvt_pk_bf16_f32 v131, v70, v71
  v_exp_f32 v72, v72
  v_exp_f32 v73, v73
  v_exp_f32 v74, v74
  v_exp_f32 v75, v75
  s_waitcnt lgkmcnt(3)
  v_mfma_f32_32x32x16_bf16 v[80:95], v[32:35], v[128:131], v[80:95]
  v_exp_f32 v76, v76
  v_exp_f32 v77, v77
  v_exp_f32 v78, v78
  v_exp_f32 v79, v79
  v_cvt_pk_bf16_f32 v132, v72, v73
  v_cvt_pk_bf16_f32 v133, v74, v75
  v_cvt_pk_bf16_f32 v134, v76, v77
  v_cvt_pk_bf16_f32 v135, v78, v79
  v_readfirstlane_b32 s3, v11
  s_cmp_ge_u32 s3, 1
  s_cbranch_scc1 L_kf02
  s_mov_b32 s60, 0
kw13:
  ds_read_b32 v11, v149
  s_add_u32 s60, s60, 1
  s_cmp_gt_u32 s60, 1600000
  s_cbranch_scc1 kw13x
  s_waitcnt lgkmcnt(0)
  v_readfirstlane_b32 s3, v11
  s_cmp_lt_u32 s3, 1
  s_cbranch_scc1 kw13
kw13x:
L_kf02:
  v_exp_f32 v48, v48
  v_exp_f32 v49, v49
  v_exp_f32 v50, v50
  v_exp_f32 v51, v51
  v_mfma_f32_32x32x16_bf16 v[80:95], v[36:39], v[132:135], v[80:95]
  v_exp_f32 v52, v52
  v_exp_f32 v53, v53
  v_exp_f32 v54, v54
  v_exp_f32 v55, v55
  s_waitcnt lgkmcnt(2)
  v_mfma_f32_32x32x16_bf16 v[64:79], v[12:15], v[4:7], v[96:111]
  ds_read_b128 v[16:19], v2 offset:3072
  s_mov_b64 exec, s[8:9]
  ds_read_b128 v[32:35], v3 offset:4096
  ds_read_b128 v[36:39], v3 offset:4608
  s_mov_b64 exec, -1
  v_cvt_pk_bf16_f32 v40, v48, v49
  v_cvt_pk_bf16_f32 v41, v50, v51
  v_cvt_pk_bf16_f32 v42, v52, v53
  v_cvt_pk_bf16_f32 v43, v54, v55
  v_exp_f32 v56, v56
  v_exp_f32 v57, v57
  v_exp_f32 v58, v58
  v_exp_f32 v59, v59
  s_waitcnt lgkmcnt(3)
  v_mfma_f32_32x32x16_bf16 v[80:95], v[24:27], v[40:43], v[80:95]
  v_exp_f32 v60, v60
  v_exp_f32 v61, v61
  v_exp_f32 v62, v62
  v_exp_f32 v63, v63
  v_cvt_pk_bf16_f32 v44, v56, v57
  v_cvt_pk_bf16_f32 v45, v58, v59
  v_cvt_pk_bf16_f32 v46, v60, v61
  v_cvt_pk_bf16_f32 v47, v62, v63
  s_setprio 2
  v_exp_f32 v64, v64
  v_exp_f32 v65, v65
  v_exp_f32 v66, v66
  v_exp_f32 v67, v67
  v_mfma_f32_32x32x16_bf16 v[80:95], v[28:31], v[44:47], v[80:95]
  v_exp_f32 v68, v68
  v_exp_f32 v69, v69
  v_exp_f32 v70, v70
  v_exp_f32 v71, v71
  s_waitcnt lgkmcnt(2)
  v_mfma_f32_32x32x16_bf16 v[48:63], v[16:19], v[4:7], v[96:111]
  ds_read_b32 v11, v149
  ds_read_b128 v[20:23], v2 offset:2048
  s_mov_b64 exec, s[8:9]
  ds_read_b128 v[24:27], v3 offset:3072
  ds_read_b128 v[28:31], v3 offset:3584
  s_mov_b64 exec, -1
  v_cvt_pk_bf16_f32 v128, v64, v65
  v_cvt_pk_bf16_f32 v129, v66, v67
  v_cvt_pk_bf16_f32 v130, v68, v69
  v_cvt_pk_bf16_f32 v131, v70, v71
  v_exp_f32 v72, v72
  v_exp_f32 v73, v73
  v_exp_f32 v74, v74
  v_exp_f32 v75, v75
  s_waitcnt lgkmcnt(3)
  v_mfma_f32_32x32x16_bf16 v[80:95], v[32:35], v[128:131], v[80:95]
  v_exp_f32 v76, v76
  v_exp_f32 v77, v77
  v_exp_f32 v78, v78
  v_exp_f32 v79, v79
  v_cvt_pk_bf16_f32 v132, v72, v73
  v_cvt_pk_bf16_f32 v133, v74, v75
  v_cvt_pk_bf16_f32 v134, v76, v77
  v_cvt_pk_bf16_f32 v135, v78, v79
  v_readfirstlane_b32 s3, v11
  s_cmp_ge_u32 s3, 2
  s_cbranch_scc1 L_kf04
  s_mov_b32 s60, 0
kw14:
  ds_read_b32 v11, v149
  s_add_u32 s60, s60, 1
  s_cmp_gt_u32 s60, 1600000
  s_cbranch_scc1 kw14x
  s_waitcnt lgkmcnt(0)
  v_readfirstlane_b32 s3, v11
  s_cmp_lt_u32 s3, 2
  s_cbranch_scc1 kw14
kw14x:
L_kf04:
  v_exp_f32 v48, v48
  v_exp_f32 v49, v49
  v_exp_f32 v50, v50
  v_exp_f32 v51, v51
  v_mfma_f32_32x32x16_bf16 v[80:95], v[36:39], v[132:135], v[80:95]
  v_exp_f32 v52, v52
  v_exp_f32 v53, v53
  v_exp_f32 v54, v54
  v_exp_f32 v55, v55
  s_waitcnt lgkmcnt(2)
  v_mfma_f32_32x32x16_bf16 v[64:79], v[20:23], v[4:7], v[96:111]
  ds_read_b128 v[12:15], v2 offset:1024
  s_mov_b64 exec, s[8:9]
  ds_read_b128 v[32:35], v3 offset:2048
  ds_read_b128 v[36:39], v3 offset:2560
  s_mov_b64 exec, -1
  v_cvt_pk_bf16_f32 v40, v48, v49
  v_cvt_pk_bf16_f32 v41, v50, v51
  v_cvt_pk_bf16_f32 v42, v52, v53
  v_cvt_pk_bf16_f32 v43, v54, v55
  v_exp_f32 v56, v56
  v_exp_f32 v57, v57
  v_exp_f32 v58, v58
  v_exp_f32 v59, v59
  s_waitcnt lgkmcnt(3)
  v_mfma_f32_32x32x16_bf16 v[80:95], v[24:27], v[40:43], v[80:95]
  v_exp_f32 v60, v60
  v_exp_f32 v61, v61
  v_exp_f32 v62, v62
  v_exp_f32 v63, v63
  v_cvt_pk_bf16_f32 v44, v56, v57
  v_cvt_pk_bf16_f32 v45, v58, v59
  v_cvt_pk_bf16_f32 v46, v60, v61
  v_cvt_pk_bf16_f32 v47, v62, v63
  s_setprio 1
  v_exp_f32 v64, v64
  v_exp_f32 v65, v65
  v_exp_f32 v66, v66
  v_exp_f32 v67, v67
  v_mfma_f32_32x32x16_bf16 v[80:95], v[28:31], v[44:47], v[80:95]
  v_exp_f32 v68, v68
  v_exp_f32 v69, v69
  v_exp_f32 v70, v70
  v_exp_f32 v71, v71
  s_waitcnt lgkmcnt(2)
  v_mfma_f32_32x32x16_bf16 v[48:63], v[12:15], v[4:7], v[96:111]
  ds_read_b128 v[16:19], v2 offset:8192
  s_mov_b64 exec, s[8:9]
  ds_read_b128 v[24:27], v3 offset:1024
  ds_read_b128 v[28:31], v3 offset:1536
  s_mov_b64 exec, -1
  v_cvt_pk_bf16_f32 v128, v64, v65
  v_cvt_pk_bf16_f32 v129, v66, v67
  v_cvt_pk_bf16_f32 v130, v68, v69
  v_cvt_pk_bf16_f32 v131, v70, v71
  v_exp_f32 v72, v72
  v_exp_f32 v73, v73
  v_exp_f32 v74, v74
  v_exp_f32 v75, v75
  s_waitcnt lgkmcnt(3)
  v_mfma_f32_32x32x16_bf16 v[80:95], v[32:35], v[128:131], v[80:95]
  v_exp_f32 v76, v76
  v_exp_f32 v77, v77
  v_exp_f32 v78, v78
  v_exp_f32 v79, v79
  v_cvt_pk_bf16_f32 v132, v72, v73
  v_cvt_pk_bf16_f32 v133, v74, v75
  v_cvt_pk_bf16_f32 v134, v76, v77
  v_cvt_pk_bf16_f32 v135, v78, v79
  v_exp_f32 v48, v48
  v_exp_f32 v49, v49
  v_exp_f32 v50, v50
  v_exp_f32 v51, v51
  v_mfma_f32_32x32x16_bf16 v[80:95], v[36:39], v[132:135], v[80:95]
  v_exp_f32 v52, v52
  v_exp_f32 v53, v53
  v_exp_f32 v54, v54
  v_exp_f32 v55, v55
  s_waitcnt lgkmcnt(2)
  v_mfma_f32_32x32x16_bf16 v[64:79], v[16:19], v[4:7], v[96:111]
  ds_read_b128 v[20:23], v2 offset:0
  s_mov_b64 exec, s[8:9]
  ds_read_b128 v[32:35], v3 offset:8192
  ds_read_b128 v[36:39], v3 offset:8704
  s_mov_b64 exec, -1
  v_cvt_pk_bf16_f32 v40, v48, v49
  v_cvt_pk_bf16_f32 v41, v50, v51
  v_cvt_pk_bf16_f32 v42, v52, v53
  v_cvt_pk_bf16_f32 v43, v54, v55
  v_exp_f32 v56, v56
  v_exp_f32 v57, v57
  v_exp_f32 v58, v58
  v_exp_f32 v59, v59
  s_waitcnt lgkmcnt(3)
  v_mfma_f32_32x32x16_bf16 v[80:95], v[24:27], v[40:43], v[80:95]
  v_exp_f32 v60, v60
  v_exp_f32 v61, v61
  s_waitcnt lgkmcnt(2)
  v_mfma_f32_32x32x16_bf16 v[112:127], v[20:23], v[4:7], v[96:111]
  v_exp_f32 v62, v62
  v_exp_f32 v63, v63
  v_cvt_pk_bf16_f32 v44, v56, v57
  v_cvt_pk_bf16_f32 v45, v58, v59
  v_cvt_pk_bf16_f32 v46, v60, v61
  v_cvt_pk_bf16_f32 v47, v62, v63
  s_setprio 0
  s_nop 1
  v_mfma_f32_32x32x16_bf16 v[80:95], v[28:31], v[44:47], v[80:95]
  s_nop 2
  v_cndmask_b32 v64, v112, v64, s[64:65]
  v_cndmask_b32 v65, v113, v65, s[66:67]
  v_cndmask_b32 v66, v114, v66, s[68:69]
  v_cndmask_b32 v67, v115, v67, s[70:71]
  v_cndmask_b32 v68, v116, v68, s[72:73]
  v_cndmask_b32 v69, v117, v69, s[74:75]
  v_cndmask_b32 v70, v118, v70, s[76:77]
  v_cndmask_b32 v71, v119, v71, s[78:79]
  v_cndmask_b32 v72, v120, v72, s[80:81]
  v_cndmask_b32 v73, v121, v73, s[82:83]
  v_cndmask_b32 v74, v122, v74, s[84:85]
  v_cndmask_b32 v75, v123, v75, s[86:87]
  v_cndmask_b32 v76, v124, v76, s[88:89]
  v_cndmask_b32 v77, v125, v77, s[90:91]
  v_cndmask_b32 v78, v126, v78, s[92:93]
  v_cndmask_b32 v79, v127, v79, s[94:95]
  v_exp_f32 v64, v64
  v_exp_f32 v65, v65
  v_exp_f32 v66, v66
  v_exp_f32 v67, v67
  s_mov_b64 exec, s[8:9]
  ds_read_b128 v[24:27], v3 offset:0
  ds_read_b128 v[28:31], v3 offset:512
  s_mov_b64 exec, -1
  v_exp_f32 v68, v68
  v_exp_f32 v69, v69
  v_exp_f32 v70, v70
  v_exp_f32 v71, v71
  v_cvt_pk_bf16_f32 v128, v64, v65
  v_cvt_pk_bf16_f32 v129, v66, v67
  v_cvt_pk_bf16_f32 v130, v68, v69
  v_cvt_pk_bf16_f32 v131, v70, v71
  v_exp_f32 v72, v72
  v_exp_f32 v73, v73
  v_exp_f32 v74, v74
  v_exp_f32 v75, v75
  v_and_b32 v40, v136, v128
  v_xor_b32 v128, v40, v128
  v_and_b32 v41, v137, v129
  v_xor_b32 v129, v41, v129
  v_and_b32 v42, v138, v130
  v_xor_b32 v130, v42, v130
  v_and_b32 v43, v139, v131
  v_xor_b32 v131, v43, v131
  s_waitcnt lgkmcnt(2)
  v_mfma_f32_32x32x16_bf16 v[80:95], v[32:35], v[40:43], v[80:95]
  v_exp_f32 v76, v76
  v_exp_f32 v77, v77
  s_waitcnt lgkmcnt(0)
  v_mfma_f32_32x32x16_bf16 v[80:95], v[24:27], v[128:131], v[80:95]
  v_exp_f32 v78, v78
  v_exp_f32 v79, v79
  v_cvt_pk_bf16_f32 v132, v72, v73
  v_cvt_pk_bf16_f32 v133, v74, v75
  v_cvt_pk_bf16_f32 v134, v76, v77
  v_cvt_pk_bf16_f32 v135, v78, v79
  v_and_b32 v44, v140, v132
  v_xor_b32 v132, v44, v132
  v_and_b32 v45, v141, v133
  v_xor_b32 v133, v45, v133
  v_and_b32 v46, v142, v134
  v_xor_b32 v134, v46, v134
  v_and_b32 v47, v143, v135
  v_xor_b32 v135, v47, v135
  s_nop 0
  v_mfma_f32_32x32x16_bf16 v[80:95], v[36:39], v[44:47], v[80:95]
  v_mfma_f32_32x32x16_bf16 v[80:95], v[28:31], v[132:135], v[80:95]
  s_waitcnt vmcnt(0)
  v_cmp_ne_u32 s[6:7], s14, v148
  v_mov_b32 v14, 0x7f800000
  s_nop 8
  v_add_f32 v10, |v80|, |v81|
  v_add_f32 v11, |v82|, |v83|
  v_add_f32 v12, |v84|, |v85|
  v_add_f32 v13, |v86|, |v87|
  v_add_f32 v10, v10, v11
  v_add_f32 v12, v12, v13
  v_mul_f32 v11, 0x43800000, v88
  v_add_f32 v10, v10, v12
  v_add_f32 v11, v10, v11
  v_rcp_f32 v10, v88
  v_cmp_lt_f32 vcc, v11, v14
  s_cmp_eq_u64 vcc, -1
  s_cbranch_scc1 L_norm
  s_branch L_slow
L_first:
  v_mov_b32 v150, v8
  v_mov_b32 v151, v8
  v_mov_b32 v152, v8
  v_mov_b32 v153, v8
  v_mov_b32 v154, v8
  v_mov_b32 v155, v8
  v_mov_b32 v156, v8
  v_mov_b32 v157, v8
  v_mov_b32 v158, v8
  v_mov_b32 v159, v8
  v_mov_b32 v160, v8
  v_mov_b32 v161, v8
  v_mov_b32 v162, v8
  v_mov_b32 v163, v8
  v_mov_b32 v164, v8
  v_mov_b32 v165, v8
  s_cmp_lt_u32 s19, 4
  s_cbranch_scc1 L_q01
  ds_read_b128 v[12:15], v2 offset:7168
  s_mov_b64 exec, s[8:9]
  ds_read_b128 v[24:27], v3 offset:7168
  ds_read_b128 v[28:31], v3 offset:7680
  s_mov_b64 exec, -1
  s_waitcnt lgkmcnt(2)
  v_mfma_f32_32x32x16_bf16 v[64:79], v[12:15], v[4:7], 0
  s_nop 11
  v_max3_f32 v9, v64, v65, v66
  v_max3_f32 v10, v67, v68, v69
  v_max3_f32 v11, v70, v71, v72
  v_max3_f32 v9, v73, v74, v9
  v_max3_f32 v10, v75, v76, v10
  v_max3_f32 v11, v77, v78, v11
  v_max3_f32 v9, v79, v9, v10
  v_max_f32 v9, v9, v11
  v_mov_b32 v10, v9
  s_nop 1
  v_permlane32_swap_b32 v10, v9
  s_nop 1
  v_max_f32 v9, v9, v10
  v_sub_f32 v96, 0xc2700000, v9
  v_mov_b32 v97, v96
  v_mov_b32 v98, v96
  v_mov_b32 v99, v96
  v_mov_b32 v100, v96
  v_mov_b32 v101, v96
  v_mov_b32 v102, v96
  v_mov_b32 v103, v96
  v_mov_b32 v104, v96
  v_mov_b32 v105, v96
  v_mov_b32 v106, v96
  v_mov_b32 v107, v96
  v_mov_b32 v108, v96
  v_mov_b32 v109, v96
  v_mov_b32 v110, v96
  v_mov_b32 v111, v96
  s_nop 1
  v_mfma_f32_32x32x16_bf16 v[48:63], v[12:15], v[4:7], v[96:111]
  s_nop 11
  v_exp_f32 v48, v48
  v_exp_f32 v49, v49
  v_exp_f32 v50, v50
  v_exp_f32 v51, v51
  v_exp_f32 v52, v52
  v_exp_f32 v53, v53
  v_exp_f32 v54, v54
  v_exp_f32 v55, v55
  v_exp_f32 v56, v56
  v_exp_f32 v57, v57
  v_exp_f32 v58, v58
  v_exp_f32 v59, v59
  v_cvt_pk_bf16_f32 v40, v48, v49
  v_cvt_pk_bf16_f32 v41, v50, v51
  v_cvt_pk_bf16_f32 v42, v52, v53
  v_cvt_pk_bf16_f32 v43, v54, v55
  v_exp_f32 v60, v60
  s_waitcnt lgkmcnt(0)
  v_mfma_f32_32x32x16_bf16 v[80:95], v[24:27], v[40:43], 0
  v_exp_f32 v61, v61
  v_exp_f32 v62, v62
  v_exp_f32 v63, v63
  v_cvt_pk_bf16_f32 v44, v56, v57
  v_cvt_pk_bf16_f32 v45, v58, v59
  v_cvt_pk_bf16_f32 v46, v60, v61
  v_cvt_pk_bf16_f32 v47, v62, v63
  s_barrier
  ds_read_b128 v[16:19], v2 offset:6144
  s_barrier
  ds_read_b128 v[20:23], v2 offset:5120
  s_mov_b64 exec, s[8:9]
  ds_read_b128 v[32:35], v3 offset:6144
  ds_read_b128 v[36:39], v3 offset:6656
  s_mov_b64 exec, -1
  s_waitcnt lgkmcnt(3)
  s_cmp_gt_u32 s10, 1
  s_cbranch_scc1 L_fv1b
  v_mfma_f32_32x32x16_bf16 v[64:79], v[16:19], v[4:7], v[150:165]
  s_branch L_fw1b
L_fv1b:
  v_mfma_f32_32x32x16_bf16 v[64:79], v[16:19], v[4:7], v[96:111]
L_fw1b:
  s_nop 10
  s_branch L_n11
L_q01:
  ds_read_b128 v[20:23], v2 offset:8192
  s_waitcnt lgkmcnt(0)
  v_mfma_f32_32x32x16_bf16 v[64:79], v[20:23], v[4:7], 0
  s_nop 11
  v_cndmask_b32 v64, v8, v64, s[64:65]
  v_cndmask_b32 v65, v8, v65, s[66:67]
  v_cndmask_b32 v66, v8, v66, s[68:69]
  v_cndmask_b32 v67, v8, v67, s[70:71]
  v_cndmask_b32 v68, v8, v68, s[72:73]
  v_cndmask_b32 v69, v8, v69, s[74:75]
  v_cndmask_b32 v70, v8, v70, s[76:77]
  v_cndmask_b32 v71, v8, v71, s[78:79]
  v_cndmask_b32 v72, v8, v72, s[80:81]
  v_cndmask_b32 v73, v8, v73, s[82:83]
  v_cndmask_b32 v74, v8, v74, s[84:85]
  v_cndmask_b32 v75, v8, v75, s[86:87]
  v_cndmask_b32 v76, v8, v76, s[88:89]
  v_cndmask_b32 v77, v8, v77, s[90:91]
  v_cndmask_b32 v78, v8, v78, s[92:93]
  v_cndmask_b32 v79, v8, v79, s[94:95]
  v_max3_f32 v9, v64, v65, v66
  v_max3_f32 v10, v67, v68, v69
  v_max3_f32 v11, v70, v71, v72
  v_max3_f32 v9, v73, v74, v9
  v_max3_f32 v10, v75, v76, v10
  v_max3_f32 v11, v77, v78, v11
  v_max3_f32 v9, v79, v9, v10
  v_max_f32 v9, v9, v11
  v_mov_b32 v10, v9
  s_nop 1
  v_permlane32_swap_b32 v10, v9
  s_nop 1
  v_max_f32 v9, v9, v10
  v_sub_f32 v96, 0xc2700000, v9
  v_mov_b32 v97, v96
  v_mov_b32 v98, v96
  v_mov_b32 v99, v96
  v_mov_b32 v100, v96
  v_mov_b32 v101, v96
  v_mov_b32 v102, v96
  v_mov_b32 v103, v96
  v_mov_b32 v104, v96
  v_mov_b32 v105, v96
  v_mov_b32 v106, v96
  v_mov_b32 v107, v96
  v_mov_b32 v108, v96
  v_mov_b32 v109, v96
  v_mov_b32 v110, v96
  v_mov_b32 v111, v96
  s_barrier
  ds_read_b128 v[12:15], v2 offset:7168
  ds_read_b128 v[16:19], v2 offset:6144
  s_mov_b64 exec, s[8:9]
  ds_read_b128 v[24:27], v3 offset:7168
  ds_read_b128 v[28:31], v3 offset:7680
  s_mov_b64 exec, -1
  s_waitcnt lgkmcnt(3)
  s_cmp_gt_u32 s10, 0
  s_cbranch_scc1 L_fv0
  v_mfma_f32_32x32x16_bf16 v[48:63], v[12:15], v[4:7], v[150:165]
  s_branch L_fw0
L_fv0:
  v_mfma_f32_32x32x16_bf16 v[48:63], v[12:15], v[4:7], v[96:111]
L_fw0:
  s_waitcnt lgkmcnt(2)
  s_cmp_gt_u32 s10, 1
  s_cbranch_scc1 L_fv1
  v_mfma_f32_32x32x16_bf16 v[64:79], v[16:19], v[4:7], v[150:165]
  s_branch L_fw1
L_fv1:
  v_mfma_f32_32x32x16_bf16 v[64:79], v[16:19], v[4:7], v[96:111]
L_fw1:
  s_barrier
  ds_read_b128 v[20:23], v2 offset:5120
  s_mov_b64 exec, s[8:9]
  ds_read_b128 v[32:35], v3 offset:6144
  ds_read_b128 v[36:39], v3 offset:6656
  s_mov_b64 exec, -1
  s_nop 3
  v_exp_f32 v48, v48
  v_exp_f32 v49, v49
  v_exp_f32 v50, v50
  v_exp_f32 v51, v51
  v_exp_f32 v52, v52
  v_exp_f32 v53, v53
  v_exp_f32 v54, v54
  v_exp_f32 v55, v55
  v_cvt_pk_bf16_f32 v40, v48, v49
  v_cvt_pk_bf16_f32 v41, v50, v51
  v_cvt_pk_bf16_f32 v42, v52, v53
  v_cvt_pk_bf16_f32 v43, v54, v55
  v_exp_f32 v56, v56
  v_exp_f32 v57, v57
  v_exp_f32 v58, v58
  v_exp_f32 v59, v59
  s_waitcnt lgkmcnt(3)
  v_mfma_f32_32x32x16_bf16 v[80:95], v[24:27], v[40:43], 0
  v_exp_f32 v60, v60
  v_exp_f32 v61, v61
  v_exp_f32 v62, v62
  v_exp_f32 v63, v63
  v_cvt_pk_bf16_f32 v44, v56, v57
  v_cvt_pk_bf16_f32 v45, v58, v59
  v_cvt_pk_bf16_f32 v46, v60, v61
  v_cvt_pk_bf16_f32 v47, v62, v63
L_n11:
  v_and_b32 v147, 31, v0
  s_lshl_b32 s3, s22, 7
  s_add_u32 s3, s3, 11927552
  v_lshl_add_u32 v147, v147, 2, s3
  buffer_load_dword v148, v147, s[32:35], 0 offen sc1
  v_exp_f32 v64, v64
  v_exp_f32 v65, v65
  v_exp_f32 v66, v66
  v_exp_f32 v67, v67
  v_mfma_f32_32x32x16_bf16 v[80:95], v[28:31], v[44:47], v[80:95]
  v_exp_f32 v68, v68
  v_exp_f32 v69, v69
  v_exp_f32 v70, v70
  v_exp_f32 v71, v71
  s_waitcnt lgkmcnt(2)
  s_cmp_gt_u32 s10, 2
  s_cbranch_scc1 L_fv2
  v_mfma_f32_32x32x16_bf16 v[48:63], v[20:23], v[4:7], v[150:165]
  s_branch L_fw2
L_fv2:
  v_mfma_f32_32x32x16_bf16 v[48:63], v[20:23], v[4:7], v[96:111]
L_fw2:
  ds_read_b32 v11, v149
  ds_read_b128 v[12:15], v2 offset:4096
  s_mov_b64 exec, s[8:9]
  ds_read_b128 v[24:27], v3 offset:5120
  ds_read_b128 v[28:31], v3 offset:5632
  s_mov_b64 exec, -1
  v_cvt_pk_bf16_f32 v128, v64, v65
  v_cvt_pk_bf16_f32 v129, v66, v67
  v_cvt_pk_bf16_f32 v130, v68, v69
  v_cvt_pk_bf16_f32 v131, v70, v71
  v_exp_f32 v72, v72
  v_exp_f32 v73, v73
  v_exp_f32 v74, v74
  v_exp_f32 v75, v75
  s_waitcnt lgkmcnt(3)
  v_mfma_f32_32x32x16_bf16 v[80:95], v[32:35], v[128:131], v[80:95]
  v_exp_f32 v76, v76
  v_exp_f32 v77, v77
  v_exp_f32 v78, v78
  v_exp_f32 v79, v79
  v_cvt_pk_bf16_f32 v132, v72, v73
  v_cvt_pk_bf16_f32 v133, v74, v75
  v_cvt_pk_bf16_f32 v134, v76, v77
  v_cvt_pk_bf16_f32 v135, v78, v79
  v_readfirstlane_b32 s3, v11
  s_cmp_ge_u32 s3, 1
  s_cbranch_scc1 L_kf12
  s_mov_b32 s60, 0
kw15:
  ds_read_b32 v11, v149
  s_add_u32 s60, s60, 1
  s_cmp_gt_u32 s60, 1600000
  s_cbranch_scc1 kw15x
  s_waitcnt lgkmcnt(0)
  v_readfirstlane_b32 s3, v11
  s_cmp_lt_u32 s3, 1
  s_cbranch_scc1 kw15
kw15x:
L_kf12:
  v_exp_f32 v48, v48
  v_exp_f32 v49, v49
  v_exp_f32 v50, v50
  v_exp_f32 v51, v51
  v_mfma_f32_32x32x16_bf16 v[80:95], v[36:39], v[132:135], v[80:95]
  v_exp_f32 v52, v52
  v_exp_f32 v53, v53
  v_exp_f32 v54, v54
  v_exp_f32 v55, v55
  s_waitcnt lgkmcnt(2)
  s_cmp_gt_u32 s10, 3
  s_cbranch_scc1 L_fv3
  v_mfma_f32_32x32x16_bf16 v[64:79], v[12:15], v[4:7], v[150:165]
  s_branch L_fw3
L_fv3:
  v_mfma_f32_32x32x16_bf16 v[64:79], v[12:15], v[4:7], v[96:111]
L_fw3:
  ds_read_b128 v[16:19], v2 offset:3072
  s_mov_b64 exec, s[8:9]
  ds_read_b128 v[32:35], v3 offset:4096
  ds_read_b128 v[36:39], v3 offset:4608
  s_mov_b64 exec, -1
  v_cvt_pk_bf16_f32 v40, v48, v49
  v_cvt_pk_bf16_f32 v41, v50, v51
  v_cvt_pk_bf16_f32 v42, v52, v53
  v_cvt_pk_bf16_f32 v43, v54, v55
  v_exp_f32 v56, v56
  v_exp_f32 v57, v57
  v_exp_f32 v58, v58
  v_exp_f32 v59, v59
  s_waitcnt lgkmcnt(3)
  v_mfma_f32_32x32x16_bf16 v[80:95], v[24:27], v[40:43], v[80:95]
  v_exp_f32 v60, v60
  v_exp_f32 v61, v61
  v_exp_f32 v62, v62
  v_exp_f32 v63, v63
  v_cvt_pk_bf16_f32 v44, v56, v57
  v_cvt_pk_bf16_f32 v45, v58, v59
  v_cvt_pk_bf16_f32 v46, v60, v61
  v_cvt_pk_bf16_f32 v47, v62, v63
  s_setprio 2
  v_exp_f32 v64, v64
  v_exp_f32 v65, v65
  v_exp_f32 v66, v66
  v_exp_f32 v67, v67
  v_mfma_f32_32x32x16_bf16 v[80:95], v[28:31], v[44:47], v[80:95]
  v_exp_f32 v68, v68
  v_exp_f32 v69, v69
  v_exp_f32 v70, v70
  v_exp_f32 v71, v71
  s_waitcnt lgkmcnt(2)
  s_cmp_gt_u32 s10, 4
  s_cbranch_scc1 L_fv4
  v_mfma_f32_32x32x16_bf16 v[48:63], v[16:19], v[4:7], v[150:165]
  s_branch L_fw4
L_fv4:
  v_mfma_f32_32x32x16_bf16 v[48:63], v[16:19], v[4:7], v[96:111]
L_fw4:
  ds_read_b32 v11, v149
  ds_read_b128 v[20:23], v2 offset:2048
  s_mov_b64 exec, s[8:9]
  ds_read_b128 v[24:27], v3 offset:3072
  ds_read_b128 v[28:31], v3 offset:3584
  s_mov_b64 exec, -1
  v_cvt_pk_bf16_f32 v128, v64, v65
  v_cvt_pk_bf16_f32 v129, v66, v67
  v_cvt_pk_bf16_f32 v130, v68, v69
  v_cvt_pk_bf16_f32 v131, v70, v71
  v_exp_f32 v72, v72
  v_exp_f32 v73, v73
  v_exp_f32 v74, v74
  v_exp_f32 v75, v75
  s_waitcnt lgkmcnt(3)
  v_mfma_f32_32x32x16_bf16 v[80:95], v[32:35], v[128:131], v[80:95]
  v_exp_f32 v76, v76
  v_exp_f32 v77, v77
  v_exp_f32 v78, v78
  v_exp_f32 v79, v79
  v_cvt_pk_bf16_f32 v132, v72, v73
  v_cvt_pk_bf16_f32 v133, v74, v75
  v_cvt_pk_bf16_f32 v134, v76, v77
  v_cvt_pk_bf16_f32 v135, v78, v79
  v_readfirstlane_b32 s3, v11
  s_cmp_ge_u32 s3, 2
  s_cbranch_scc1 L_kf14
  s_mov_b32 s60, 0
kw16:
  ds_read_b32 v11, v149
  s_add_u32 s60, s60, 1
  s_cmp_gt_u32 s60, 1600000
  s_cbranch_scc1 kw16x
  s_waitcnt lgkmcnt(0)
  v_readfirstlane_b32 s3, v11
  s_cmp_lt_u32 s3, 2
  s_cbranch_scc1 kw16
kw16x:
L_kf14:
  v_exp_f32 v48, v48
  v_exp_f32 v49, v49
  v_exp_f32 v50, v50
  v_exp_f32 v51, v51
  v_mfma_f32_32x32x16_bf16 v[80:95], v[36:39], v[132:135], v[80:95]
  v_exp_f32 v52, v52
  v_exp_f32 v53, v53
  v_exp_f32 v54, v54
  v_exp_f32 v55, v55
  s_waitcnt lgkmcnt(2)
  s_cmp_gt_u32 s10, 5
  s_cbranch_scc1 L_fv5
  v_mfma_f32_32x32x16_bf16 v[64:79], v[20:23], v[4:7], v[150:165]
  s_branch L_fw5
L_fv5:
  v_mfma_f32_32x32x16_bf16 v[64:79], v[20:23], v[4:7], v[96:111]
L_fw5:
  ds_read_b128 v[12:15], v2 offset:1024
  s_mov_b64 exec, s[8:9]
  ds_read_b128 v[32:35], v3 offset:2048
  ds_read_b128 v[36:39], v3 offset:2560
  s_mov_b64 exec, -1
  v_cvt_pk_bf16_f32 v40, v48, v49
  v_cvt_pk_bf16_f32 v41, v50, v51
  v_cvt_pk_bf16_f32 v42, v52, v53
  v_cvt_pk_bf16_f32 v43, v54, v55
  v_exp_f32 v56, v56
  v_exp_f32 v57, v57
  v_exp_f32 v58, v58
  v_exp_f32 v59, v59
  s_waitcnt lgkmcnt(3)
  v_mfma_f32_32x32x16_bf16 v[80:95], v[24:27], v[40:43], v[80:95]
  v_exp_f32 v60, v60
  v_exp_f32 v61, v61
  v_exp_f32 v62, v62
  v_exp_f32 v63, v63
  v_cvt_pk_bf16_f32 v44, v56, v57
  v_cvt_pk_bf16_f32 v45, v58, v59
  v_cvt_pk_bf16_f32 v46, v60, v61
  v_cvt_pk_bf16_f32 v47, v62, v63
  s_setprio 1
  v_exp_f32 v64, v64
  v_exp_f32 v65, v65
  v_exp_f32 v66, v66
  v_exp_f32 v67, v67
  v_mfma_f32_32x32x16_bf16 v[80:95], v[28:31], v[44:47], v[80:95]
  v_exp_f32 v68, v68
  v_exp_f32 v69, v69
  v_exp_f32 v70, v70
  v_exp_f32 v71, v71
  s_waitcnt lgkmcnt(2)
  s_cmp_gt_u32 s10, 6
  s_cbranch_scc1 L_fv6
  v_mfma_f32_32x32x16_bf16 v[48:63], v[12:15], v[4:7], v[150:165]
  s_branch L_fw6
L_fv6:
  v_mfma_f32_32x32x16_bf16 v[48:63], v[12:15], v[4:7], v[96:111]
L_fw6:
  ds_read_b128 v[16:19], v2 offset:8192
  s_mov_b64 exec, s[8:9]
  ds_read_b128 v[24:27], v3 offset:1024
  ds_read_b128 v[28:31], v3 offset:1536
  s_mov_b64 exec, -1
  v_cvt_pk_bf16_f32 v128, v64, v65
  v_cvt_pk_bf16_f32 v129, v66, v67
  v_cvt_pk_bf16_f32 v130, v68, v69
  v_cvt_pk_bf16_f32 v131, v70, v71
  v_exp_f32 v72, v72
  v_exp_f32 v73, v73
  v_exp_f32 v74, v74
  v_exp_f32 v75, v75
  s_waitcnt lgkmcnt(3)
  v_mfma_f32_32x32x16_bf16 v[80:95], v[32:35], v[128:131], v[80:95]
  v_exp_f32 v76, v76
  v_exp_f32 v77, v77
  v_exp_f32 v78, v78
  v_exp_f32 v79, v79
  v_cvt_pk_bf16_f32 v132, v72, v73
  v_cvt_pk_bf16_f32 v133, v74, v75
  v_cvt_pk_bf16_f32 v134, v76, v77
  v_cvt_pk_bf16_f32 v135, v78, v79
  v_exp_f32 v48, v48
  v_exp_f32 v49, v49
  v_exp_f32 v50, v50
  v_exp_f32 v51, v51
  v_mfma_f32_32x32x16_bf16 v[80:95], v[36:39], v[132:135], v[80:95]
  v_exp_f32 v52, v52
  v_exp_f32 v53, v53
  v_exp_f32 v54, v54
  v_exp_f32 v55, v55
  s_waitcnt lgkmcnt(2)
  v_mfma_f32_32x32x16_bf16 v[64:79], v[16:19], v[4:7], v[96:111]
  ds_read_b128 v[20:23], v2 offset:0
  s_mov_b64 exec, s[8:9]
  ds_read_b128 v[32:35], v3 offset:8192
  ds_read_b128 v[36:39], v3 offset:8704
  s_mov_b64 exec, -1
  v_cvt_pk_bf16_f32 v40, v48, v49
  v_cvt_pk_bf16_f32 v41, v50, v51
  v_cvt_pk_bf16_f32 v42, v52, v53
  v_cvt_pk_bf16_f32 v43, v54, v55
  v_exp_f32 v56, v56
  v_exp_f32 v57, v57
  v_exp_f32 v58, v58
  v_exp_f32 v59, v59
  s_waitcnt lgkmcnt(3)
  v_mfma_f32_32x32x16_bf16 v[80:95], v[24:27], v[40:43], v[80:95]
  v_exp_f32 v60, v60
  v_exp_f32 v61, v61
  s_waitcnt lgkmcnt(2)
  v_mfma_f32_32x32x16_bf16 v[112:127], v[20:23], v[4:7], v[150:165]
  v_exp_f32 v62, v62
  v_exp_f32 v63, v63
  v_cvt_pk_bf16_f32 v44, v56, v57
  v_cvt_pk_bf16_f32 v45, v58, v59
  v_cvt_pk_bf16_f32 v46, v60, v61
  v_cvt_pk_bf16_f32 v47, v62, v63
  s_setprio 0
  s_nop 1
  v_mfma_f32_32x32x16_bf16 v[80:95], v[28:31], v[44:47], v[80:95]
  s_nop 2
  v_cndmask_b32 v64, v112, v64, s[64:65]
  v_cndmask_b32 v65, v113, v65, s[66:67]
  v_cndmask_b32 v66, v114, v66, s[68:69]
  v_cndmask_b32 v67, v115, v67, s[70:71]
  v_cndmask_b32 v68, v116, v68, s[72:73]
  v_cndmask_b32 v69, v117, v69, s[74:75]
  v_cndmask_b32 v70, v118, v70, s[76:77]
  v_cndmask_b32 v71, v119, v71, s[78:79]
  v_cndmask_b32 v72, v120, v72, s[80:81]
  v_cndmask_b32 v73, v121, v73, s[82:83]
  v_cndmask_b32 v74, v122, v74, s[84:85]
  v_cndmask_b32 v75, v123, v75, s[86:87]
  v_cndmask_b32 v76, v124, v76, s[88:89]
  v_cndmask_b32 v77, v125, v77, s[90:91]
  v_cndmask_b32 v78, v126, v78, s[92:93]
  v_cndmask_b32 v79, v127, v79, s[94:95]
  v_exp_f32 v64, v64
  v_exp_f32 v65, v65
  v_exp_f32 v66, v66
  v_exp_f32 v67, v67
  s_mov_b64 exec, s[8:9]
  ds_read_b128 v[24:27], v3 offset:0
  ds_read_b128 v[28:31], v3 offset:512
  s_mov_b64 exec, -1
  v_exp_f32 v68, v68
  v_exp_f32 v69, v69
  v_exp_f32 v70, v70
  v_exp_f32 v71, v71
  v_cvt_pk_bf16_f32 v128, v64, v65
  v_cvt_pk_bf16_f32 v129, v66, v67
  v_cvt_pk_bf16_f32 v130, v68, v69
  v_cvt_pk_bf16_f32 v131, v70, v71
  v_exp_f32 v72, v72
  v_exp_f32 v73, v73
  v_exp_f32 v74, v74
  v_exp_f32 v75, v75
  v_and_b32 v40, v136, v128
  v_xor_b32 v128, v40, v128
  v_and_b32 v41, v137, v129
  v_xor_b32 v129, v41, v129
  v_and_b32 v42, v138, v130
  v_xor_b32 v130, v42, v130
  v_and_b32 v43, v139, v131
  v_xor_b32 v131, v43, v131
  s_waitcnt lgkmcnt(2)
  v_mfma_f32_32x32x16_bf16 v[80:95], v[32:35], v[40:43], v[80:95]
  v_exp_f32 v76, v76
  v_exp_f32 v77, v77
  s_waitcnt lgkmcnt(0)
  v_mfma_f32_32x32x16_bf16 v[80:95], v[24:27], v[128:131], v[80:95]
  v_exp_f32 v78, v78
  v_exp_f32 v79, v79
  v_cvt_pk_bf16_f32 v132, v72, v73
  v_cvt_pk_bf16_f32 v133, v74, v75
  v_cvt_pk_bf16_f32 v134, v76, v77
  v_cvt_pk_bf16_f32 v135, v78, v79
  v_and_b32 v44, v140, v132
  v_xor_b32 v132, v44, v132
  v_and_b32 v45, v141, v133
  v_xor_b32 v133, v45, v133
  v_and_b32 v46, v142, v134
  v_xor_b32 v134, v46, v134
  v_and_b32 v47, v143, v135
  v_xor_b32 v135, v47, v135
  s_nop 0
  v_mfma_f32_32x32x16_bf16 v[80:95], v[36:39], v[44:47], v[80:95]
  v_mfma_f32_32x32x16_bf16 v[80:95], v[28:31], v[132:135], v[80:95]
  s_waitcnt vmcnt(0)
  v_cmp_ne_u32 s[6:7], s14, v148
  v_mov_b32 v14, 0x7f800000
  s_nop 8
  v_add_f32 v10, |v80|, |v81|
  v_add_f32 v11, |v82|, |v83|
  v_add_f32 v12, |v84|, |v85|
  v_add_f32 v13, |v86|, |v87|
  v_add_f32 v10, v10, v11
  v_add_f32 v12, v12, v13
  v_mul_f32 v11, 0x43800000, v88
  v_add_f32 v10, v10, v12
  v_add_f32 v11, v10, v11
  v_rcp_f32 v10, v88
  v_cmp_lt_f32 vcc, v11, v14
  s_cmp_eq_u64 vcc, -1
  s_cbranch_scc1 L_norm
  s_branch L_slow
L_preslow:
  s_barrier
  s_barrier
  s_mov_b32 s60, 0
kw17:
  ds_read_b32 v11, v149
  s_add_u32 s60, s60, 1
  s_cmp_gt_u32 s60, 1600000
  s_cbranch_scc1 kw17x
  s_waitcnt lgkmcnt(0)
  v_readfirstlane_b32 s3, v11
  s_cmp_lt_u32 s3, 2
  s_cbranch_scc1 kw17
kw17x:
  v_and_b32 v147, 31, v0
  s_lshl_b32 s3, s22, 7
  s_add_u32 s3, s3, 11927552
  v_lshl_add_u32 v147, v147, 2, s3
  buffer_load_dword v148, v147, s[32:35], 0 offen sc1
L_slow:
  s_setprio 0
  s_sub_u32 s3, 8, s10
  s_lshl_b32 s3, s3, 10
  s_waitcnt lgkmcnt(0)
  v_cndmask_b32 v112, v8, 0, s[64:65]
  v_cndmask_b32 v128, 0, v8, s[64:65]
  v_cndmask_b32 v113, v8, 0, s[66:67]
  v_cndmask_b32 v129, 0, v8, s[66:67]
  v_cndmask_b32 v114, v8, 0, s[68:69]
  v_cndmask_b32 v130, 0, v8, s[68:69]
  v_cndmask_b32 v115, v8, 0, s[70:71]
  v_cndmask_b32 v131, 0, v8, s[70:71]
  v_cndmask_b32 v116, v8, 0, s[72:73]
  v_cndmask_b32 v132, 0, v8, s[72:73]
  v_cndmask_b32 v117, v8, 0, s[74:75]
  v_cndmask_b32 v133, 0, v8, s[74:75]
  v_cndmask_b32 v118, v8, 0, s[76:77]
  v_cndmask_b32 v134, 0, v8, s[76:77]
  v_cndmask_b32 v119, v8, 0, s[78:79]
  v_cndmask_b32 v135, 0, v8, s[78:79]
  v_cndmask_b32 v120, v8, 0, s[80:81]
  v_cndmask_b32 v136, 0, v8, s[80:81]
  v_cndmask_b32 v121, v8, 0, s[82:83]
  v_cndmask_b32 v137, 0, v8, s[82:83]
  v_cndmask_b32 v122, v8, 0, s[84:85]
  v_cndmask_b32 v138, 0, v8, s[84:85]
  v_cndmask_b32 v123, v8, 0, s[86:87]
  v_cndmask_b32 v139, 0, v8, s[86:87]
  v_cndmask_b32 v124, v8, 0, s[88:89]
  v_cndmask_b32 v140, 0, v8, s[88:89]
  v_cndmask_b32 v125, v8, 0, s[90:91]
  v_cndmask_b32 v141, 0, v8, s[90:91]
  v_cndmask_b32 v126, v8, 0, s[92:93]
  v_cndmask_b32 v142, 0, v8, s[92:93]
  v_cndmask_b32 v127, v8, 0, s[94:95]
  v_cndmask_b32 v143, 0, v8, s[94:95]
  ds_read_b128 v[12:15], v2 offset:8192
  s_waitcnt lgkmcnt(0)
  v_mfma_f32_32x32x16_bf16 v[48:63], v[12:15], v[4:7], v[112:127]
  s_nop 11
  v_max_f32 v9, v48, v49
  v_max3_f32 v9, v50, v51, v9
  v_max3_f32 v9, v52, v53, v9
  v_max3_f32 v9, v54, v55, v9
  v_max3_f32 v9, v56, v57, v9
  v_max3_f32 v9, v58, v59, v9
  v_max3_f32 v9, v60, v61, v9
  v_max3_f32 v9, v62, v63, v9
  s_cmp_eq_u32 s22, 0
  s_cbranch_scc1 L_s1nofar
  ds_read_b128 v[12:15], v2
  s_waitcnt lgkmcnt(0)
  v_mfma_f32_32x32x16_bf16 v[48:63], v[12:15], v[4:7], v[128:143]
  s_nop 11
  v_max3_f32 v9, v48, v49, v9
  v_max3_f32 v9, v50, v51, v9
  v_max3_f32 v9, v52, v53, v9
  v_max3_f32 v9, v54, v55, v9
  v_max3_f32 v9, v56, v57, v9
  v_max3_f32 v9, v58, v59, v9
  v_max3_f32 v9, v60, v61, v9
  v_max3_f32 v9, v62, v63, v9
L_s1nofar:
  s_mov_b32 s11, s10
  v_add_u32 v10, s3, v2
  s_cmp_eq_u32 s11, 0
  s_cbranch_scc1 L_s1done
L_s1loop:
  ds_read_b128 v[12:15], v10
  v_add_u32 v10, 1024, v10
  s_waitcnt lgkmcnt(0)
  v_mfma_f32_32x32x16_bf16 v[48:63], v[12:15], v[4:7], 0
  s_nop 11
  v_max3_f32 v9, v48, v49, v9
  v_max3_f32 v9, v50, v51, v9
  v_max3_f32 v9, v52, v53, v9
  v_max3_f32 v9, v54, v55, v9
  v_max3_f32 v9, v56, v57, v9
  v_max3_f32 v9, v58, v59, v9
  v_max3_f32 v9, v60, v61, v9
  v_max3_f32 v9, v62, v63, v9
  s_sub_u32 s11, s11, 1
  s_cmp_lg_u32 s11, 0
  s_cbranch_scc1 L_s1loop
L_s1done:
  v_mov_b32 v10, v9
  s_nop 1
  v_permlane32_swap_b32 v10, v9
  s_nop 1
  v_max_f32 v9, v9, v10
  v_sub_f32 v9, 0, v9
  v_cndmask_b32 v112, v8, v9, s[64:65]
  v_cndmask_b32 v128, v9, v8, s[64:65]
  v_cndmask_b32 v113, v8, v9, s[66:67]
  v_cndmask_b32 v129, v9, v8, s[66:67]
  v_cndmask_b32 v114, v8, v9, s[68:69]
  v_cndmask_b32 v130, v9, v8, s[68:69]
  v_cndmask_b32 v115, v8, v9, s[70:71]
  v_cndmask_b32 v131, v9, v8, s[70:71]
  v_cndmask_b32 v116, v8, v9, s[72:73]
  v_cndmask_b32 v132, v9, v8, s[72:73]
  v_cndmask_b32 v117, v8, v9, s[74:75]
  v_cndmask_b32 v133, v9, v8, s[74:75]
  v_cndmask_b32 v118, v8, v9, s[76:77]
  v_cndmask_b32 v134, v9, v8, s[76:77]
  v_cndmask_b32 v119, v8, v9, s[78:79]
  v_cndmask_b32 v135, v9, v8, s[78:79]
  v_cndmask_b32 v120, v8, v9, s[80:81]
  v_cndmask_b32 v136, v9, v8, s[80:81]
  v_cndmask_b32 v121, v8, v9, s[82:83]
  v_cndmask_b32 v137, v9, v8, s[82:83]
  v_cndmask_b32 v122, v8, v9, s[84:85]
  v_cndmask_b32 v138, v9, v8, s[84:85]
  v_cndmask_b32 v123, v8, v9, s[86:87]
  v_cndmask_b32 v139, v9, v8, s[86:87]
  v_cndmask_b32 v124, v8, v9, s[88:89]
  v_cndmask_b32 v140, v9, v8, s[88:89]
  v_cndmask_b32 v125, v8, v9, s[90:91]
  v_cndmask_b32 v141, v9, v8, s[90:91]
  v_cndmask_b32 v126, v8, v9, s[92:93]
  v_cndmask_b32 v142, v9, v8, s[92:93]
  v_cndmask_b32 v127, v8, v9, s[94:95]
  v_cndmask_b32 v143, v9, v8, s[94:95]
  v_mov_b32 v96, v9
  v_mov_b32 v97, v9
  v_mov_b32 v98, v9
  v_mov_b32 v99, v9
  v_mov_b32 v100, v9
  v_mov_b32 v101, v9
  v_mov_b32 v102, v9
  v_mov_b32 v103, v9
  v_mov_b32 v104, v9
  v_mov_b32 v105, v9
  v_mov_b32 v106, v9
  v_mov_b32 v107, v9
  v_mov_b32 v108, v9
  v_mov_b32 v109, v9
  v_mov_b32 v110, v9
  v_mov_b32 v111, v9
  ds_read_b128 v[12:15], v2 offset:8192
  s_mov_b64 exec, s[8:9]
  ds_read_b128 v[24:27], v3 offset:8192
  ds_read_b128 v[28:31], v3 offset:8704
  s_mov_b64 exec, -1
  s_waitcnt lgkmcnt(0)
  v_mfma_f32_32x32x16_bf16 v[48:63], v[12:15], v[4:7], v[112:127]
  s_nop 11
  v_exp_f32 v48, v48
  v_exp_f32 v49, v49
  v_exp_f32 v50, v50
  v_exp_f32 v51, v51
  v_exp_f32 v52, v52
  v_exp_f32 v53, v53
  v_exp_f32 v54, v54
  v_exp_f32 v55, v55
  v_exp_f32 v56, v56
  v_exp_f32 v57, v57
  v_exp_f32 v58, v58
  v_exp_f32 v59, v59
  v_exp_f32 v60, v60
  v_exp_f32 v61, v61
  v_exp_f32 v62, v62
  v_exp_f32 v63, v63
  v_cvt_pk_bf16_f32 v40, v48, v49
  v_cvt_pk_bf16_f32 v41, v50, v51
  v_cvt_pk_bf16_f32 v42, v52, v53
  v_cvt_pk_bf16_f32 v43, v54, v55
  v_cvt_pk_bf16_f32 v44, v56, v57
  v_cvt_pk_bf16_f32 v45, v58, v59
  v_cvt_pk_bf16_f32 v46, v60, v61
  v_cvt_pk_bf16_f32 v47, v62, v63
  s_nop 1
  v_mfma_f32_32x32x16_bf16 v[80:95], v[24:27], v[40:43], 0
  v_mfma_f32_32x32x16_bf16 v[80:95], v[28:31], v[44:47], v[80:95]
  s_cmp_eq_u32 s22, 0
  s_cbranch_scc1 L_s2nofar
  ds_read_b128 v[12:15], v2 offset:0
  s_mov_b64 exec, s[8:9]
  ds_read_b128 v[24:27], v3 offset:0
  ds_read_b128 v[28:31], v3 offset:512
  s_mov_b64 exec, -1
  s_waitcnt lgkmcnt(0)
  v_mfma_f32_32x32x16_bf16 v[48:63], v[12:15], v[4:7], v[128:143]
  s_nop 11
  v_exp_f32 v48, v48
  v_exp_f32 v49, v49
  v_exp_f32 v50, v50
  v_exp_f32 v51, v51
  v_exp_f32 v52, v52
  v_exp_f32 v53, v53
  v_exp_f32 v54, v54
  v_exp_f32 v55, v55
  v_exp_f32 v56, v56
  v_exp_f32 v57, v57
  v_exp_f32 v58, v58
  v_exp_f32 v59, v59
  v_exp_f32 v60, v60
  v_exp_f32 v61, v61
  v_exp_f32 v62, v62
  v_exp_f32 v63, v63
  v_cvt_pk_bf16_f32 v40, v48, v49
  v_cvt_pk_bf16_f32 v41, v50, v51
  v_cvt_pk_bf16_f32 v42, v52, v53
  v_cvt_pk_bf16_f32 v43, v54, v55
  v_cvt_pk_bf16_f32 v44, v56, v57
  v_cvt_pk_bf16_f32 v45, v58, v59
  v_cvt_pk_bf16_f32 v46, v60, v61
  v_cvt_pk_bf16_f32 v47, v62, v63
  s_nop 1
  v_mfma_f32_32x32x16_bf16 v[80:95], v[24:27], v[40:43], v[80:95]
  v_mfma_f32_32x32x16_bf16 v[80:95], v[28:31], v[44:47], v[80:95]
L_s2nofar:
  s_mov_b32 s11, s10
  v_add_u32 v10, s3, v2
  v_add_u32 v11, s3, v3
  s_cmp_eq_u32 s11, 0
  s_cbranch_scc1 L_s2done
L_s2loop:
  ds_read_b128 v[12:15], v10 offset:0
  s_mov_b64 exec, s[8:9]
  ds_read_b128 v[24:27], v11 offset:0
  ds_read_b128 v[28:31], v11 offset:512
  s_mov_b64 exec, -1
  s_waitcnt lgkmcnt(0)
  v_mfma_f32_32x32x16_bf16 v[48:63], v[12:15], v[4:7], v[96:111]
  s_nop 11
  v_exp_f32 v48, v48
  v_exp_f32 v49, v49
  v_exp_f32 v50, v50
  v_exp_f32 v51, v51
  v_exp_f32 v52, v52
  v_exp_f32 v53, v53
  v_exp_f32 v54, v54
  v_exp_f32 v55, v55
  v_exp_f32 v56, v56
  v_exp_f32 v57, v57
  v_exp_f32 v58, v58
  v_exp_f32 v59, v59
  v_exp_f32 v60, v60
  v_exp_f32 v61, v61
  v_exp_f32 v62, v62
  v_exp_f32 v63, v63
  v_cvt_pk_bf16_f32 v40, v48, v49
  v_cvt_pk_bf16_f32 v41, v50, v51
  v_cvt_pk_bf16_f32 v42, v52, v53
  v_cvt_pk_bf16_f32 v43, v54, v55
  v_cvt_pk_bf16_f32 v44, v56, v57
  v_cvt_pk_bf16_f32 v45, v58, v59
  v_cvt_pk_bf16_f32 v46, v60, v61
  v_cvt_pk_bf16_f32 v47, v62, v63
  s_nop 1
  v_mfma_f32_32x32x16_bf16 v[80:95], v[24:27], v[40:43], v[80:95]
  v_mfma_f32_32x32x16_bf16 v[80:95], v[28:31], v[44:47], v[80:95]
  v_add_u32 v10, 1024, v10
  v_add_u32 v11, 1024, v11
  s_sub_u32 s11, s11, 1
  s_cmp_lg_u32 s11, 0
  s_cbranch_scc1 L_s2loop
L_s2done:
  s_waitcnt vmcnt(0)
  v_cmp_ne_u32 s[6:7], s14, v148
  s_nop 12
  v_rcp_f32 v10, v88
  s_nop 0
L_norm:
  v_mul_f32 v80, v10, v80
  v_mul_f32 v81, v10, v81
  v_mul_f32 v82, v10, v82
  v_mul_f32 v83, v10, v83
  v_mul_f32 v84, v10, v84
  v_mul_f32 v85, v10, v85
  v_mul_f32 v86, v10, v86
  v_mul_f32 v87, v10, v87
  v_cvt_pk_bf16_f32 v40, v80, v81
  v_cvt_pk_bf16_f32 v41, v82, v83
  v_cvt_pk_bf16_f32 v42, v84, v85
  v_cvt_pk_bf16_f32 v43, v86, v87
  s_add_u32 s4, s12, 6291456
  s_cmp_eq_u64 s[6:7], 0
  s_cbranch_scc0 L_ox
  buffer_store_dwordx4 v[40:43], v1, s[32:35], s4 offen
  s_waitcnt vmcnt(0)
  v_mov_b32 v10, s20
  s_mov_b64 exec, 1
  buffer_store_dword v10, off, s[32:35], s13
  s_mov_b64 exec, -1
  s_branch L_od
L_ox:
  buffer_store_dwordx4 v[40:43], v1, s[32:35], s4 offen sc1
  s_waitcnt vmcnt(0)
  v_mov_b32 v10, s20
  s_mov_b64 exec, 1
  buffer_store_dword v10, off, s[32:35], s13 sc1
  s_mov_b64 exec, -1
L_od:
  s_barrier
  s_cmp_ge_u32 s19, 4
  s_cbranch_scc1 L_fin
  s_and_b32 s5, s19, 1
  v_lshrrev_b32 v2, 5, v0
  v_bfe_u32 v3, v0, 2, 2
  v_lshl_add_u32 v4, v2, 2, v3
  v_lshlrev_b32 v4, 7, v4
  v_bfe_u32 v5, v0, 4, 1
  v_lshlrev_b32 v5, 1, v5
  v_and_b32 v6, 1, v0
  v_add_u32 v5, v5, v6
  s_and_b32 s3, s19, 2
  s_lshl_b32 s3, s3, 1
  v_add_u32 v5, s3, v5
  v_bfe_u32 v6, v0, 3, 1
  v_lshlrev_b32 v6, 2, v6
  v_xor_b32 v5, v5, v6
  v_lshl_add_u32 v4, v5, 4, v4
  v_bfe_u32 v6, v0, 1, 1
  v_lshl_add_u32 v4, v6, 3, v4
  v_add_u32 v9, 98304, v4
  s_lshl_b32 s3, s5, 10
  v_add_u32 v8, s3, v1
  v_and_b32 v14, 31, v0
  s_lshl_b32 s3, s16, 6
  s_lshl_b32 s5, s5, 5
  s_add_u32 s3, s3, s5
  v_add_u32 v14, s3, v14
  v_lshlrev_b32 v14, 11, v14
  v_lshl_add_u32 v14, v2, 4, v14
  s_lshl_b32 s3, s17, 7
  s_and_b32 s5, s19, 2
  s_lshl_b32 s5, s5, 5
  s_add_u32 s3, s3, s5
  s_add_u32 s3, s3, 1024
  v_add_u32 v14, s3, v14
  v_mov_b32 v15, v8
  ds_read_b64_tr_b16 v[32:33], v9 offset:0
  ds_read_b64_tr_b16 v[34:35], v9 offset:1024
  ds_read_b64_tr_b16 v[36:37], v9 offset:2048
  ds_read_b64_tr_b16 v[38:39], v9 offset:3072
  ds_read_b64_tr_b16 v[40:41], v9 offset:4096
  ds_read_b64_tr_b16 v[42:43], v9 offset:5120
  ds_read_b64_tr_b16 v[44:45], v9 offset:6144
  ds_read_b64_tr_b16 v[46:47], v9 offset:7168
  ds_read_b64_tr_b16 v[48:49], v9 offset:16384
  ds_read_b64_tr_b16 v[50:51], v9 offset:17408
  ds_read_b64_tr_b16 v[52:53], v9 offset:18432
  ds_read_b64_tr_b16 v[54:55], v9 offset:19456
  ds_read_b64_tr_b16 v[56:57], v9 offset:20480
  ds_read_b64_tr_b16 v[58:59], v9 offset:21504
  ds_read_b64_tr_b16 v[60:61], v9 offset:22528
  ds_read_b64_tr_b16 v[62:63], v9 offset:23552
  ds_read_b64_tr_b16 v[64:65], v9 offset:32768
  ds_read_b64_tr_b16 v[66:67], v9 offset:33792
  ds_read_b64_tr_b16 v[68:69], v9 offset:34816
  ds_read_b64_tr_b16 v[70:71], v9 offset:35840
  ds_read_b64_tr_b16 v[72:73], v9 offset:36864
  ds_read_b64_tr_b16 v[74:75], v9 offset:37888
  ds_read_b64_tr_b16 v[76:77], v9 offset:38912
  ds_read_b64_tr_b16 v[78:79], v9 offset:39936
  ds_read_b64_tr_b16 v[80:81], v9 offset:49152
  ds_read_b64_tr_b16 v[82:83], v9 offset:50176
  ds_read_b64_tr_b16 v[84:85], v9 offset:51200
  ds_read_b64_tr_b16 v[86:87], v9 offset:52224
  ds_read_b64_tr_b16 v[88:89], v9 offset:53248
  ds_read_b64_tr_b16 v[90:91], v9 offset:54272
  ds_read_b64_tr_b16 v[92:93], v9 offset:55296
  ds_read_b64_tr_b16 v[94:95], v9 offset:56320
  ds_read_b64_tr_b16 v[96:97], v9 offset:8192
  ds_read_b64_tr_b16 v[98:99], v9 offset:9216
  ds_read_b64_tr_b16 v[100:101], v9 offset:10240
  ds_read_b64_tr_b16 v[102:103], v9 offset:11264
  ds_read_b64_tr_b16 v[104:105], v9 offset:12288
  ds_read_b64_tr_b16 v[106:107], v9 offset:13312
  ds_read_b64_tr_b16 v[108:109], v9 offset:14336
  ds_read_b64_tr_b16 v[110:111], v9 offset:15360
  ds_read_b64_tr_b16 v[112:113], v9 offset:24576
  ds_read_b64_tr_b16 v[114:115], v9 offset:25600
  ds_read_b64_tr_b16 v[116:117], v9 offset:26624
  ds_read_b64_tr_b16 v[118:119], v9 offset:27648
  ds_read_b64_tr_b16 v[120:121], v9 offset:28672
  ds_read_b64_tr_b16 v[122:123], v9 offset:29696
  ds_read_b64_tr_b16 v[124:125], v9 offset:30720
  ds_read_b64_tr_b16 v[126:127], v9 offset:31744
  ds_read_b64_tr_b16 v[128:129], v9 offset:40960
  ds_read_b64_tr_b16 v[130:131], v9 offset:41984
  ds_read_b64_tr_b16 v[132:133], v9 offset:43008
  ds_read_b64_tr_b16 v[134:135], v9 offset:44032
  ds_read_b64_tr_b16 v[136:137], v9 offset:45056
  ds_read_b64_tr_b16 v[138:139], v9 offset:46080
  ds_read_b64_tr_b16 v[140:141], v9 offset:47104
  ds_read_b64_tr_b16 v[142:143], v9 offset:48128
  ds_read_b64_tr_b16 v[144:145], v9 offset:57344
  ds_read_b64_tr_b16 v[146:147], v9 offset:58368
  ds_read_b64_tr_b16 v[148:149], v9 offset:59392
  ds_read_b64_tr_b16 v[150:151], v9 offset:60416
  ds_read_b64_tr_b16 v[152:153], v9 offset:61440
  ds_read_b64_tr_b16 v[154:155], v9 offset:62464
  ds_read_b64_tr_b16 v[156:157], v9 offset:63488
  ds_read_b64_tr_b16 v[158:159], v9 offset:64512
  s_waitcnt lgkmcnt(0)
  s_barrier
  ds_read_b128 v[2:5], v15 offset:0
  ds_read_b128 v[6:9], v15 offset:2048
  ds_read_b128 v[10:13], v15 offset:4096
  ds_read_b128 v[160:163], v15 offset:6144
  s_waitcnt lgkmcnt(3)
  v_mfma_f32_32x32x16_bf16 v[16:31], v[32:35], v[2:5], 0
  ds_read_b128 v[2:5], v15 offset:16384
  s_waitcnt lgkmcnt(3)
  v_mfma_f32_32x32x16_bf16 v[16:31], v[36:39], v[6:9], v[16:31]
  ds_read_b128 v[6:9], v15 offset:18432
  s_waitcnt lgkmcnt(3)
  v_mfma_f32_32x32x16_bf16 v[16:31], v[40:43], v[10:13], v[16:31]
  ds_read_b128 v[10:13], v15 offset:20480
  s_waitcnt lgkmcnt(3)
  v_mfma_f32_32x32x16_bf16 v[16:31], v[44:47], v[160:163], v[16:31]
  ds_read_b128 v[160:163], v15 offset:22528
  s_waitcnt lgkmcnt(3)
  v_mfma_f32_32x32x16_bf16 v[16:31], v[48:51], v[2:5], v[16:31]
  ds_read_b128 v[2:5], v15 offset:32768
  s_waitcnt lgkmcnt(3)
  v_mfma_f32_32x32x16_bf16 v[16:31], v[52:55], v[6:9], v[16:31]
  ds_read_b128 v[6:9], v15 offset:34816
  s_waitcnt lgkmcnt(3)
  v_mfma_f32_32x32x16_bf16 v[16:31], v[56:59], v[10:13], v[16:31]
  ds_read_b128 v[10:13], v15 offset:36864
  s_waitcnt lgkmcnt(3)
  v_mfma_f32_32x32x16_bf16 v[16:31], v[60:63], v[160:163], v[16:31]
  ds_read_b128 v[160:163], v15 offset:38912
  s_waitcnt lgkmcnt(3)
  v_mfma_f32_32x32x16_bf16 v[16:31], v[64:67], v[2:5], v[16:31]
  ds_read_b128 v[2:5], v15 offset:49152
  s_waitcnt lgkmcnt(3)
  v_mfma_f32_32x32x16_bf16 v[16:31], v[68:71], v[6:9], v[16:31]
  ds_read_b128 v[6:9], v15 offset:51200
  s_waitcnt lgkmcnt(3)
  v_mfma_f32_32x32x16_bf16 v[16:31], v[72:75], v[10:13], v[16:31]
  ds_read_b128 v[10:13], v15 offset:53248
  s_waitcnt lgkmcnt(3)
  v_mfma_f32_32x32x16_bf16 v[16:31], v[76:79], v[160:163], v[16:31]
  ds_read_b128 v[160:163], v15 offset:55296
  s_barrier
  s_waitcnt lgkmcnt(3)
  v_mfma_f32_32x32x16_bf16 v[16:31], v[80:83], v[2:5], v[16:31]
  ds_read_b128 v[2:5], v15 offset:8192
  s_waitcnt lgkmcnt(3)
  v_mfma_f32_32x32x16_bf16 v[16:31], v[84:87], v[6:9], v[16:31]
  ds_read_b128 v[6:9], v15 offset:10240
  s_waitcnt lgkmcnt(3)
  v_mfma_f32_32x32x16_bf16 v[16:31], v[88:91], v[10:13], v[16:31]
  ds_read_b128 v[10:13], v15 offset:12288
  s_waitcnt lgkmcnt(3)
  v_mfma_f32_32x32x16_bf16 v[16:31], v[92:95], v[160:163], v[16:31]
  ds_read_b128 v[160:163], v15 offset:14336
  s_waitcnt lgkmcnt(3)
  v_mfma_f32_32x32x16_bf16 v[16:31], v[96:99], v[2:5], v[16:31]
  ds_read_b128 v[2:5], v15 offset:24576
  s_waitcnt lgkmcnt(3)
  v_mfma_f32_32x32x16_bf16 v[16:31], v[100:103], v[6:9], v[16:31]
  ds_read_b128 v[6:9], v15 offset:26624
  s_waitcnt lgkmcnt(3)
  v_mfma_f32_32x32x16_bf16 v[16:31], v[104:107], v[10:13], v[16:31]
  ds_read_b128 v[10:13], v15 offset:28672
  s_waitcnt lgkmcnt(3)
  v_mfma_f32_32x32x16_bf16 v[16:31], v[108:111], v[160:163], v[16:31]
  ds_read_b128 v[160:163], v15 offset:30720
  s_waitcnt lgkmcnt(3)
  v_mfma_f32_32x32x16_bf16 v[16:31], v[112:115], v[2:5], v[16:31]
  ds_read_b128 v[2:5], v15 offset:40960
  s_waitcnt lgkmcnt(3)
  v_mfma_f32_32x32x16_bf16 v[16:31], v[116:119], v[6:9], v[16:31]
  ds_read_b128 v[6:9], v15 offset:43008
  s_waitcnt lgkmcnt(3)
  v_mfma_f32_32x32x16_bf16 v[16:31], v[120:123], v[10:13], v[16:31]
  ds_read_b128 v[10:13], v15 offset:45056
  s_waitcnt lgkmcnt(3)
  v_mfma_f32_32x32x16_bf16 v[16:31], v[124:127], v[160:163], v[16:31]
  ds_read_b128 v[160:163], v15 offset:47104
  s_waitcnt lgkmcnt(3)
  v_mfma_f32_32x32x16_bf16 v[16:31], v[128:131], v[2:5], v[16:31]
  ds_read_b128 v[2:5], v15 offset:57344
  s_waitcnt lgkmcnt(3)
  v_mfma_f32_32x32x16_bf16 v[16:31], v[132:135], v[6:9], v[16:31]
  ds_read_b128 v[6:9], v15 offset:59392
  s_waitcnt lgkmcnt(3)
  v_mfma_f32_32x32x16_bf16 v[16:31], v[136:139], v[10:13], v[16:31]
  ds_read_b128 v[10:13], v15 offset:61440
  s_waitcnt lgkmcnt(3)
  v_mfma_f32_32x32x16_bf16 v[16:31], v[140:143], v[160:163], v[16:31]
  ds_read_b128 v[160:163], v15 offset:63488
  s_waitcnt lgkmcnt(3)
  v_mfma_f32_32x32x16_bf16 v[16:31], v[144:147], v[2:5], v[16:31]
  s_waitcnt lgkmcnt(2)
  v_mfma_f32_32x32x16_bf16 v[16:31], v[148:151], v[6:9], v[16:31]
  s_waitcnt lgkmcnt(1)
  v_mfma_f32_32x32x16_bf16 v[16:31], v[152:155], v[10:13], v[16:31]
  s_waitcnt lgkmcnt(0)
  v_mfma_f32_32x32x16_bf16 v[16:31], v[156:159], v[160:163], v[16:31]
  s_nop 11
  v_cvt_pk_bf16_f32 v32, v16, v17
  v_cvt_pk_bf16_f32 v33, v18, v19
  v_cvt_pk_bf16_f32 v34, v20, v21
  v_cvt_pk_bf16_f32 v35, v22, v23
  buffer_store_dwordx4 v[32:35], v14, s[40:43], 0 offen offset:0
  v_cvt_pk_bf16_f32 v36, v24, v25
  v_cvt_pk_bf16_f32 v37, v26, v27
  v_cvt_pk_bf16_f32 v38, v28, v29
  v_cvt_pk_bf16_f32 v39, v30, v31
  buffer_store_dwordx4 v[36:39], v14, s[40:43], 0 offen offset:32
L_fin:
L_end:
L_last_insn:
  s_endpgm
.section .rodata,"a"
.p2align 6
.amdhsa_kernel concat_heads__spectral_fnet__sliding_block__prompt_kernel
  .amdhsa_next_free_vgpr 168
  .amdhsa_next_free_sgpr 102
  .amdhsa_accum_offset 168
  .amdhsa_group_segment_fixed_size 0
  .amdhsa_kernarg_size 88
  .amdhsa_user_sgpr_count 2
  .amdhsa_user_sgpr_kernarg_segment_ptr 1
  .amdhsa_system_sgpr_workgroup_id_x 1
.end_amdhsa_kernel
```
